```python
import torch

def _softmax(x, axis=-1):
    return torch.softmax(x, dim=axis)
def _gelu(x):
    return torch.nn.functional.gelu(x, approximate="tanh")
def _silu(x):
    return torch.nn.functional.silu(x)
def _sigmoid(x):
    return torch.sigmoid(x)
def _layernorm(x, axis=-1, eps=1e-5):
    m = x.mean(dim=axis, keepdim=True)
    v = x.var(dim=axis, keepdim=True, unbiased=False)
    return (x - m) / torch.sqrt(v + eps)
def _scatter_add(tgt, idx, src, axis=0):
    return tgt.clone().index_add_(axis, idx, src)
def _segment_sum(src, seg, n):
    out = torch.zeros((n,) + src.shape[1:], dtype=src.dtype)
    return out.index_add_(0, seg, src)
def _pad(x, pw):
    flat = tuple(v for pair in reversed(pw) for v in pair)
    return torch.nn.functional.pad(x, flat)

kernel_name = 'parallel_sum__ssm_conv_s5__mixer_channel_mlp__prompt'

def setup_inputs():

    _w = (lambda a: (lambda t: t.to(torch.bfloat16) if t.is_floating_point() else t)(torch.as_tensor(a)))
    def _A_setup():
        B, S, D = 1, 2048, 448
        P = D
        Lambda_re = -0.5 * (lambda _x: torch.exp(torch.as_tensor(_x)))((lambda *s: torch.randn(*s, dtype=torch.bfloat16) * 0.2)(P))
        Lambda_im = (lambda *s: torch.randn(*s, dtype=torch.bfloat16) * 0.8)(P) * 1.0
        B_re = (lambda *s: torch.randn(*s, dtype=torch.bfloat16) * 0.2)(P, D) * (D ** -0.5)
        B_im = (lambda *s: torch.randn(*s, dtype=torch.bfloat16) * 0.2)(P, D) * (D ** -0.5)
        C_re = (lambda *s: torch.randn(*s, dtype=torch.bfloat16) * 0.2)(D, P) * (P ** -0.5)
        C_im = (lambda *s: torch.randn(*s, dtype=torch.bfloat16) * 0.2)(D, P) * (P ** -0.5)
        log_dt = (lambda *s: torch.randn(*s, dtype=torch.bfloat16) * 0.2)(P) * 0.3 - 2.0
        Dskip = (lambda *s: torch.randn(*s, dtype=torch.bfloat16) * 0.05)(D)
        return {
            "x": _w((lambda *s: torch.randn(*s, dtype=torch.bfloat16) * 0.05)(B, S, D)),
            "Lambda_re": _w(Lambda_re),
            "Lambda_im": _w(Lambda_im),
            "B_re": _w(B_re),
            "B_im": _w(B_im),
            "C_re": _w(C_re),
            "C_im": _w(C_im),
            "log_dt": _w(log_dt),
            "Dskip": _w(Dskip),
        }
    _A_in = _A_setup()

    def _B_setup():
        B, S, D, F = 1, 2048, 448, 1792
        return {
            "x": _w((lambda *s: torch.randn(*s, dtype=torch.bfloat16) * 0.05)(B, S, D)),
            "w1": _w((lambda *s: torch.randn(*s, dtype=torch.bfloat16) * 1.6)(D, F) * (D ** -0.5)),
            "b1": _w((lambda *s: torch.randn(*s, dtype=torch.bfloat16) * 0.8)(F)),
            "w2": _w((lambda *s: torch.randn(*s, dtype=torch.bfloat16) * 0.05)(F, D) * (F ** -0.5)),
            "b2": _w((lambda *s: torch.randn(*s, dtype=torch.bfloat16) * 0.05)(D)),
        }
    _B_in = _B_setup()

    return {
        "A_x": _A_in["x"],
        "A_Lambda_re": _A_in["Lambda_re"],
        "A_Lambda_im": _A_in["Lambda_im"],
        "A_B_re": _A_in["B_re"],
        "A_B_im": _A_in["B_im"],
        "A_C_re": _A_in["C_re"],
        "A_C_im": _A_in["C_im"],
        "A_log_dt": _A_in["log_dt"],
        "A_Dskip": _A_in["Dskip"],
        "B_x": _B_in["x"],
        "B_w1": _B_in["w1"],
        "B_b1": _B_in["b1"],
        "B_w2": _B_in["w2"],
        "B_b2": _B_in["b2"],
    }

def reference(A_x, A_Lambda_re, A_Lambda_im, A_B_re, A_B_im, A_C_re, A_C_im, A_log_dt, A_Dskip, B_x, B_w1, B_b1, B_w2, B_b2):
    def _A_ref(x, Lambda_re, Lambda_im, B_re, B_im, C_re, C_im, log_dt, Dskip):
        Bsz, L, H = x.shape
        Lam = Lambda_re + 1j * Lambda_im
        Bmat = B_re + 1j * B_im
        Cmat = C_re + 1j * C_im
        dt = torch.exp(log_dt)
        Lam_bar = torch.exp(dt * Lam)
        B_bar = ((Lam_bar - 1.0) / Lam)[:, None] * Bmat
        Bu = torch.einsum("bld,pd->blp", x + 0j, B_bar)
        h = torch.zeros_like(Bu[:, 0, :])
        hs = []
        for t in range(L):
            h = Lam_bar[None, :] * h + Bu[:, t, :]
            hs.append(h)
        hseq = torch.stack(hs, 1)
        y = 2.0 * torch.einsum("blp,dp->bld", hseq, Cmat).real + x * Dskip[None, None, :]
        return y

    def _B_ref(x, w1, b1, w2, b2):
        y = _layernorm(x, axis=-1)
        h = _gelu(torch.einsum("bsd,df->bsf", y, w1) + b1)
        return torch.einsum("bsf,fd->bsd", h, w2) + b2

    x = A_x
    xn = _layernorm(x, axis=-1)
    return x + _A_ref(xn, A_Lambda_re, A_Lambda_im, A_B_re, A_B_im, A_C_re, A_C_im, A_log_dt, A_Dskip) + _B_ref(xn, B_w1, B_b1, B_w2, B_b2)
```

```asm
; @launch grid=(256,1,1) block=(256,1,1) lds=163840
.amdgcn_target "amdgcn-amd-amdhsa--gfx950"
.text
.globl parallel_sum__ssm_conv_s5__mixer_channel_mlp__prompt_kernel
.p2align 8
.type parallel_sum__ssm_conv_s5__mixer_channel_mlp__prompt_kernel,@function
parallel_sum__ssm_conv_s5__mixer_channel_mlp__prompt_kernel:
s_cmp_ge_u32 s2, 256
s_cbranch_scc1 L_exit
s_load_dwordx16 s[64:79], s[0:1], 0
s_load_dwordx2 s[6:7], s[0:1], 128
s_load_dwordx8 s[84:91], s[0:1], 80
s_load_dwordx4 s[92:95], s[0:1], 112
s_load_dwordx2 s[80:81], s[0:1], 64
s_getpc_b64 s[52:53]
L_pc:
v_lshrrev_b32 v1, 6, v0
v_and_b32 v0, 63, v0
s_and_b32 s98, s2, 7
v_readfirstlane_b32 s3, v1
s_lshr_b32 s99, s2, 3
s_sub_u32 s99, s99, 4
s_and_b32 s4, s98, 3
s_lshl_b32 s4, s4, 3
s_lshr_b32 s98, s98, 2
s_lshl_b32 s50, s98, 2
s_lshr_b32 s5, s99, 3
s_add_u32 s5, s5, s50
s_and_b32 s51, s99, 7
s_add_u32 s50, s50, s51
s_cmp_ge_u32 s99, 24
s_cselect_b32 s5, 3, s5
s_cmp_ge_u32 s99, 24
s_cselect_b32 s51, s50, s51
s_add_u32 s4, s4, s51
s_lshr_b32 s48, s3, 1
s_and_b32 s49, s3, 1
s_lshl_b32 s54, s3, 11
s_cmp_lt_u32 s2, 32
s_cbranch_scc1 L_help
v_lshrrev_b32 v46, 3, v0
s_lshl_b32 s98, s3, 4
v_add_u32 v46, s98, v46
v_and_b32 v47, 7, v0
v_lshrrev_b32 v48, 4, v0
v_mul_u32_u24 v49, 896, v46
v_xor_b32 v1, v47, v48
v_lshl_add_u32 v4, v1, 4, v49
v_add_u32 v1, 4, v48
v_xor_b32 v1, v47, v1
v_lshl_add_u32 v5, v1, 4, v49
v_add_u32 v5, 6144, v5
v_and_b32 v1, 1, v48
v_lshlrev_b32 v1, 2, v1
v_xor_b32 v1, v47, v1
v_lshl_add_u32 v6, v1, 4, v49
v_add_u32 v7, 6144, v6
v_mul_u32_u24 v49, 3584, v46
v_lshl_add_u32 v8, v1, 4, v49
v_add_u32 v9, 27648, v8
s_mul_i32 s98, s4, 57344
s_mul_i32 s99, s5, 57344
s_mov_b32 s10, 57344
s_mov_b32 s11, 0x20000
s_mov_b32 s14, 57344
s_mov_b32 s15, 0x20000
s_mov_b32 s18, 57344
s_mov_b32 s19, 0x20000
s_waitcnt lgkmcnt(0)
s_add_u32 s8, s64, s98
s_addc_u32 s9, s65, 0
s_add_u32 s12, s70, s99
s_addc_u32 s13, s71, 0
s_add_u32 s16, s72, s99
s_addc_u32 s17, s73, 0
s_add_u32 m0, s54, 122880
s_nop 0
buffer_load_dwordx4 v4, s[8:11], 0 offen lds
buffer_load_dwordx4 v5, s[8:11], 0 offen offset:1024 lds
s_add_u32 m0, s54, 131072
s_mov_b32 s55, 128
buffer_load_dwordx4 v4, s[8:11], s55 offen lds
buffer_load_dwordx4 v5, s[8:11], s55 offen offset:1024 lds
s_add_u32 m0, s54, 139264
s_mov_b32 s55, 256
buffer_load_dwordx4 v4, s[8:11], s55 offen lds
buffer_load_dwordx4 v5, s[8:11], s55 offen offset:1024 lds
s_add_u32 m0, s54, 147456
s_mov_b32 s55, 384
buffer_load_dwordx4 v4, s[8:11], s55 offen lds
buffer_load_dwordx4 v5, s[8:11], s55 offen offset:1024 lds
s_add_u32 m0, s54, 0
s_mov_b32 s55, 512
buffer_load_dwordx4 v4, s[8:11], s55 offen lds
buffer_load_dwordx4 v5, s[8:11], s55 offen offset:1024 lds
s_add_u32 m0, s54, 8192
s_mov_b32 s55, 640
buffer_load_dwordx4 v4, s[8:11], s55 offen lds
buffer_load_dwordx4 v5, s[8:11], s55 offen offset:1024 lds
s_add_u32 m0, s54, 16384
s_mov_b32 s55, 768
buffer_load_dwordx4 v4, s[8:11], s55 offen lds
buffer_load_dwordx4 v5, s[8:11], s55 offen offset:1024 lds
s_mov_b32 s56, 0x3f803f80
s_mov_b32 s57, 0x00003f80
s_mov_b32 s58, 0x3f800000
s_mov_b32 s59, 0xffff0000
v_and_b32 v46, 31, v0
v_lshrrev_b32 v47, 5, v0
s_lshl_b32 s98, s49, 5
v_add_u32 v1, s98, v46
v_lshlrev_b32 v1, 7, v1
v_bfe_u32 v2, v46, 1, 3
v_add_u32 v3, 0, v47
v_xor_b32 v3, v3, v2
v_lshl_add_u32 v10, v3, 4, v1
v_add_u32 v14, 0x10000, v10
v_add_u32 v3, 2, v47
v_xor_b32 v3, v3, v2
v_lshl_add_u32 v11, v3, 4, v1
v_add_u32 v15, 0x10000, v11
v_add_u32 v3, 4, v47
v_xor_b32 v3, v3, v2
v_lshl_add_u32 v12, v3, 4, v1
v_add_u32 v16, 0x10000, v12
v_add_u32 v3, 6, v47
v_xor_b32 v3, v3, v2
v_lshl_add_u32 v13, v3, 4, v1
v_add_u32 v17, 0x10000, v13
v_bfe_u32 v1, v0, 2, 2
v_bfe_u32 v2, v0, 4, 1
v_lshlrev_b32 v2, 1, v2
v_bfe_u32 v3, v0, 1, 1
v_add_u32 v2, v2, v3
s_lshl_b32 s98, s49, 2
v_add_u32 v2, s98, v2
v_bfe_u32 v3, v0, 3, 1
v_lshlrev_b32 v3, 2, v3
v_xor_b32 v2, v2, v3
v_lshlrev_b32 v2, 4, v2
v_and_b32 v3, 1, v0
v_lshl_add_u32 v2, v3, 3, v2
v_lshl_add_u32 v2, v1, 7, v2
v_lshl_add_u32 v18, v47, 10, v2
v_add_u32 v19, 0x10000, v18
v_lshl_add_u32 v20, v47, 9, v2
v_add_u32 v21, 0x10000, v20
v_lshlrev_b32 v248, 4, v0
s_add_u32 s98, s54, 122880
v_add_u32 v22, s98, v248
s_lshl_b32 s98, s48, 12
s_add_u32 s98, s98, 122880
v_add_u32 v23, s98, v248
s_lshl_b32 s98, s48, 13
s_lshl_b32 s99, s49, 11
s_add_u32 s98, s98, s99
s_add_u32 s98, s98, 139264
v_lshlrev_b32 v1, 6, v46
v_lshl_add_u32 v1, v47, 5, v1
v_add_u32 v24, s98, v1
v_and_b32 v1, 1, v0
v_lshlrev_b32 v1, 4, v1
v_bfe_u32 v2, v0, 4, 1
v_lshlrev_b32 v2, 1, v2
v_bfe_u32 v3, v0, 1, 1
v_add_u32 v2, v2, v3
v_lshl_add_u32 v1, v2, 2, v1
v_lshlrev_b32 v1, 1, v1
v_bfe_u32 v2, v0, 2, 2
v_lshl_add_u32 v2, v47, 3, v2
v_lshl_add_u32 v1, v2, 6, v1
s_lshl_b32 s98, s48, 13
s_add_u32 s98, s98, 139264
v_add_u32 v25, s98, v1
s_lshl_b32 s98, s48, 7
s_add_u32 s98, s98, 156672
v_lshlrev_b32 v1, 6, v47
v_add_u32 v26, s98, v1
s_lshl_b32 s98, s49, 7
s_add_u32 s98, s98, 157184
v_lshlrev_b32 v1, 4, v47
v_add_u32 v27, s98, v1
s_lshl_b32 s98, s49, 8
s_add_u32 s98, s98, 160256
v_lshlrev_b32 v1, 3, v46
v_add_u32 v27, s98, v1
s_nop 0
s_lshl_b32 s98, s49, 10
s_add_u32 s98, s98, 158208
v_lshlrev_b32 v1, 3, v46
v_add_u32 v28, s98, v1
v_mov_b32 v29, 0xbdd2d3e8
s_lshl_b32 s98, s48, 1
v_add_u32 v1, s98, v47
v_cmp_eq_u32 s[60:61], 1, v1
v_cmp_eq_u32 s[62:63], 2, v1
v_cmp_eq_u32 s[96:97], 3, v1
s_lshl_b32 s98, s48, 5
v_lshl_add_u32 v1, v47, 4, s98
s_lshl_b32 s98, s5, 6
s_lshl_b32 s99, s49, 5
s_add_u32 s98, s98, s99
v_add_u32 v2, s98, v46
v_mul_u32_u24 v3, 448, v1
v_add_u32 v3, v3, v2
v_lshlrev_b32 v253, 1, v3
v_lshlrev_b32 v252, 2, v3
v_bfe_u32 v1, v46, 2, 1
v_lshlrev_b32 v1, 4, v1
v_lshrrev_b32 v2, 3, v46
v_lshl_add_u32 v1, v2, 2, v1
v_and_b32 v2, 3, v46
v_add_u32 v48, v1, v2
v_bfe_u32 v2, v48, 1, 3
s_lshl_b32 s98, s48, 5
v_add_u32 v1, s98, v48
v_lshlrev_b32 v1, 7, v1
v_add_u32 v3, 0, v47
v_xor_b32 v3, v3, v2
v_lshl_add_u32 v212, v3, 4, v1
v_add_u32 v216, 122880, v212
v_add_u32 v3, 2, v47
v_xor_b32 v3, v3, v2
v_lshl_add_u32 v213, v3, 4, v1
v_add_u32 v217, 122880, v213
v_add_u32 v3, 4, v47
v_xor_b32 v3, v3, v2
v_lshl_add_u32 v214, v3, 4, v1
v_add_u32 v218, 122880, v214
v_add_u32 v3, 6, v47
v_xor_b32 v3, v3, v2
v_lshl_add_u32 v215, v3, 4, v1
v_add_u32 v219, 122880, v215
s_cmp_eq_u32 s49, 0
s_cselect_b64 vcc, -1, 0
v_cndmask_b32 v208, v214, v212, vcc
v_cndmask_b32 v209, v215, v213, vcc
v_add_u32 v210, 122880, v208
v_add_u32 v211, 122880, v209
v_mov_b32 v220, 0
v_mov_b32 v221, 0
v_mov_b32 v222, 0
v_mov_b32 v223, 0
v_and_b32 v1, 31, v0
s_lshl_b32 s98, s5, 6
s_lshl_b32 s99, s49, 5
s_add_u32 s98, s98, s99
v_add_u32 v1, s98, v1
v_lshlrev_b32 v1, 1, v1
s_lshl_b32 s98, s3, 6
v_add_u32 v2, s98, v0
s_lshl_b32 s98, s5, 8
v_add_u32 v3, s98, v2
v_lshlrev_b32 v3, 1, v3
s_add_u32 m0, s54, 24576
s_nop 0
buffer_load_dwordx4 v4, s[12:15], 0 offen lds
buffer_load_dwordx4 v5, s[12:15], 0 offen offset:1024 lds
s_add_u32 m0, s54, 32768
s_mov_b32 s55, 128
buffer_load_dwordx4 v4, s[12:15], s55 offen lds
buffer_load_dwordx4 v5, s[12:15], s55 offen offset:1024 lds
global_load_ushort v32, v1, s[66:67]
global_load_ushort v33, v1, s[68:69]
global_load_ushort v34, v1, s[78:79]
global_load_ushort v250, v1, s[80:81]
global_load_ushort v251, v1, s[90:91]
global_load_ushort v249, v3, s[86:87]
s_lshl_b32 s98, s5, 9
s_add_u32 s20, s84, s98
s_addc_u32 s21, s85, 0
s_sub_u32 s22, 1605632, s98
s_mov_b32 s23, 0x20000
s_lshl_b32 s98, s5, 1
s_add_u32 s98, s98, s49
s_lshl_b32 s98, s98, 13
s_add_u32 s98, s98, 65536
s_add_u32 s36, s6, s98
s_addc_u32 s37, s7, 0
s_mov_b32 s38, 8192
s_mov_b32 s39, 0x20000
v_bfe_u32 v1, v0, 2, 1
v_bfe_u32 v2, v0, 4, 1
v_cmp_eq_u32 vcc, v1, v2
v_mov_b32 v1, 0
v_mov_b32 v2, s56
v_cndmask_b32 v1, v1, v2, vcc
v_accvgpr_write_b32 a208, v1
v_accvgpr_write_b32 a209, v1
v_accvgpr_write_b32 a210, v1
v_accvgpr_write_b32 a211, v1
s_sub_u32 s50, s5, 4
s_lshl_b32 s50, s50, 13
s_lshl_b32 s51, s5, 13
s_add_u32 s51, s51, 122880
s_cmp_lt_u32 s5, 4
s_cselect_b32 s50, s51, s50
s_lshl_b32 s51, s48, 12
s_add_u32 s50, s50, s51
v_bfe_u32 v1, v0, 2, 2
v_lshrrev_b32 v2, 5, v0
v_lshl_add_u32 v2, v2, 4, v1
v_lshlrev_b32 v2, 7, v2
v_add_u32 v2, s50, v2
v_and_b32 v3, 1, v0
v_lshl_add_u32 v2, v3, 3, v2
v_bfe_u32 v3, v0, 4, 1
v_lshlrev_b32 v3, 1, v3
v_bfe_u32 v229, v0, 1, 1
v_add_u32 v3, v3, v229
s_lshl_b32 s51, s49, 2
v_add_u32 v3, s51, v3
v_lshrrev_b32 v1, 1, v1
v_add_u32 v229, 0, v1
v_xor_b32 v229, v229, v3
v_lshl_add_u32 v229, v229, 4, v2
v_add_u32 v230, 2, v1
v_xor_b32 v230, v230, v3
v_lshl_add_u32 v230, v230, 4, v2
v_add_u32 v230, 512, v230
v_add_u32 v231, 4, v1
v_xor_b32 v231, v231, v3
v_lshl_add_u32 v231, v231, 4, v2
v_add_u32 v231, 1024, v231
v_add_u32 v232, 6, v1
v_xor_b32 v232, v232, v3
v_lshl_add_u32 v232, v232, 4, v2
v_add_u32 v232, 1536, v232
s_lshl_b32 s98, s48, 7
v_lshlrev_b32 v224, 2, v48
v_add_u32 v224, s98, v224
v_add_u32 v224, 156672, v224
s_waitcnt vmcnt(16)
s_barrier
ds_read_b128 v[152:155], v210 offset:0
ds_read_b128 v[156:159], v211 offset:0
ds_read_b128 v[160:163], v210 offset:8192
ds_read_b128 v[164:167], v211 offset:8192
ds_read_b128 v[168:171], v210 offset:16384
ds_read_b128 v[172:175], v211 offset:16384
ds_read_b128 v[176:179], v210 offset:24576
ds_read_b128 v[180:183], v211 offset:24576
s_waitcnt lgkmcnt(7)
v_dot2_f32_bf16 v220, v152, s56, v220
v_dot2_f32_bf16 v222, v152, v152, v222
v_dot2_f32_bf16 v221, v153, s56, v221
v_dot2_f32_bf16 v223, v153, v153, v223
v_dot2_f32_bf16 v220, v154, s56, v220
v_dot2_f32_bf16 v222, v154, v154, v222
v_dot2_f32_bf16 v221, v155, s56, v221
v_dot2_f32_bf16 v223, v155, v155, v223
s_waitcnt lgkmcnt(6)
v_dot2_f32_bf16 v220, v156, s56, v220
v_dot2_f32_bf16 v222, v156, v156, v222
v_dot2_f32_bf16 v221, v157, s56, v221
v_dot2_f32_bf16 v223, v157, v157, v223
v_dot2_f32_bf16 v220, v158, s56, v220
v_dot2_f32_bf16 v222, v158, v158, v222
v_dot2_f32_bf16 v221, v159, s56, v221
v_dot2_f32_bf16 v223, v159, v159, v223
ds_read_b128 a[0:3], v216 offset:0
ds_read_b128 a[4:7], v217 offset:0
ds_read_b128 a[8:11], v218 offset:0
ds_read_b128 a[12:15], v219 offset:0
s_waitcnt lgkmcnt(9)
v_dot2_f32_bf16 v220, v160, s56, v220
v_dot2_f32_bf16 v222, v160, v160, v222
v_dot2_f32_bf16 v221, v161, s56, v221
v_dot2_f32_bf16 v223, v161, v161, v223
v_dot2_f32_bf16 v220, v162, s56, v220
v_dot2_f32_bf16 v222, v162, v162, v222
v_dot2_f32_bf16 v221, v163, s56, v221
v_dot2_f32_bf16 v223, v163, v163, v223
s_waitcnt lgkmcnt(8)
v_dot2_f32_bf16 v220, v164, s56, v220
v_dot2_f32_bf16 v222, v164, v164, v222
v_dot2_f32_bf16 v221, v165, s56, v221
v_dot2_f32_bf16 v223, v165, v165, v223
v_dot2_f32_bf16 v220, v166, s56, v220
v_dot2_f32_bf16 v222, v166, v166, v222
v_dot2_f32_bf16 v221, v167, s56, v221
v_dot2_f32_bf16 v223, v167, v167, v223
ds_read_b128 a[16:19], v216 offset:8192
ds_read_b128 a[20:23], v217 offset:8192
ds_read_b128 a[24:27], v218 offset:8192
ds_read_b128 a[28:31], v219 offset:8192
s_waitcnt lgkmcnt(11)
v_dot2_f32_bf16 v220, v168, s56, v220
v_dot2_f32_bf16 v222, v168, v168, v222
v_dot2_f32_bf16 v221, v169, s56, v221
v_dot2_f32_bf16 v223, v169, v169, v223
v_dot2_f32_bf16 v220, v170, s56, v220
v_dot2_f32_bf16 v222, v170, v170, v222
v_dot2_f32_bf16 v221, v171, s56, v221
v_dot2_f32_bf16 v223, v171, v171, v223
s_waitcnt lgkmcnt(10)
v_dot2_f32_bf16 v220, v172, s56, v220
v_dot2_f32_bf16 v222, v172, v172, v222
v_dot2_f32_bf16 v221, v173, s56, v221
v_dot2_f32_bf16 v223, v173, v173, v223
v_dot2_f32_bf16 v220, v174, s56, v220
v_dot2_f32_bf16 v222, v174, v174, v222
v_dot2_f32_bf16 v221, v175, s56, v221
v_dot2_f32_bf16 v223, v175, v175, v223
ds_read_b128 a[32:35], v216 offset:16384
ds_read_b128 a[36:39], v217 offset:16384
ds_read_b128 a[40:43], v218 offset:16384
ds_read_b128 a[44:47], v219 offset:16384
s_waitcnt lgkmcnt(13)
v_dot2_f32_bf16 v220, v176, s56, v220
v_dot2_f32_bf16 v222, v176, v176, v222
v_dot2_f32_bf16 v221, v177, s56, v221
v_dot2_f32_bf16 v223, v177, v177, v223
v_dot2_f32_bf16 v220, v178, s56, v220
v_dot2_f32_bf16 v222, v178, v178, v222
v_dot2_f32_bf16 v221, v179, s56, v221
v_dot2_f32_bf16 v223, v179, v179, v223
s_waitcnt lgkmcnt(12)
v_dot2_f32_bf16 v220, v180, s56, v220
v_dot2_f32_bf16 v222, v180, v180, v222
v_dot2_f32_bf16 v221, v181, s56, v221
v_dot2_f32_bf16 v223, v181, v181, v223
v_dot2_f32_bf16 v220, v182, s56, v220
v_dot2_f32_bf16 v222, v182, v182, v222
v_dot2_f32_bf16 v221, v183, s56, v221
v_dot2_f32_bf16 v223, v183, v183, v223
ds_read_b128 a[48:51], v216 offset:24576
ds_read_b128 a[52:55], v217 offset:24576
ds_read_b128 a[56:59], v218 offset:24576
ds_read_b128 a[60:63], v219 offset:24576
s_waitcnt vmcnt(10)
s_barrier
ds_read_b128 v[184:187], v208 offset:0
ds_read_b128 v[188:191], v209 offset:0
ds_read_b128 v[192:195], v208 offset:8192
ds_read_b128 v[196:199], v209 offset:8192
ds_read_b128 v[200:203], v208 offset:16384
ds_read_b128 v[204:207], v209 offset:16384
ds_read_b64_tr_b16 a[212:213], v229
ds_read_b64_tr_b16 a[214:215], v230
ds_read_b64_tr_b16 a[216:217], v231
ds_read_b64_tr_b16 a[218:219], v232
s_waitcnt lgkmcnt(9)
v_dot2_f32_bf16 v220, v184, s56, v220
s_add_u32 m0, s54, 40960
s_mov_b32 s55, 256
buffer_load_dwordx4 v4, s[12:15], s55 offen lds
v_dot2_f32_bf16 v222, v184, v184, v222
v_dot2_f32_bf16 v221, v185, s56, v221
v_dot2_f32_bf16 v223, v185, v185, v223
v_dot2_f32_bf16 v220, v186, s56, v220
v_dot2_f32_bf16 v222, v186, v186, v222
v_dot2_f32_bf16 v221, v187, s56, v221
buffer_load_dwordx4 v5, s[12:15], s55 offen offset:1024 lds
v_dot2_f32_bf16 v223, v187, v187, v223
s_waitcnt lgkmcnt(8)
v_dot2_f32_bf16 v220, v188, s56, v220
v_dot2_f32_bf16 v222, v188, v188, v222
v_dot2_f32_bf16 v221, v189, s56, v221
v_dot2_f32_bf16 v223, v189, v189, v223
v_dot2_f32_bf16 v220, v190, s56, v220
s_add_u32 m0, s54, 49152
s_mov_b32 s55, 384
buffer_load_dwordx4 v4, s[12:15], s55 offen lds
v_dot2_f32_bf16 v222, v190, v190, v222
v_dot2_f32_bf16 v221, v191, s56, v221
v_dot2_f32_bf16 v223, v191, v191, v223
ds_read_b128 a[64:67], v212 offset:0
ds_read_b128 a[68:71], v213 offset:0
ds_read_b128 a[72:75], v214 offset:0
buffer_load_dwordx4 v5, s[12:15], s55 offen offset:1024 lds
ds_read_b128 a[76:79], v215 offset:0
s_waitcnt lgkmcnt(11)
v_dot2_f32_bf16 v220, v192, s56, v220
v_dot2_f32_bf16 v222, v192, v192, v222
v_dot2_f32_bf16 v221, v193, s56, v221
v_dot2_f32_bf16 v223, v193, v193, v223
v_dot2_f32_bf16 v220, v194, s56, v220
s_add_u32 m0, s54, 57344
s_mov_b32 s55, 512
buffer_load_dwordx4 v4, s[12:15], s55 offen lds
v_dot2_f32_bf16 v222, v194, v194, v222
v_dot2_f32_bf16 v221, v195, s56, v221
v_dot2_f32_bf16 v223, v195, v195, v223
s_waitcnt lgkmcnt(10)
v_dot2_f32_bf16 v220, v196, s56, v220
v_dot2_f32_bf16 v222, v196, v196, v222
v_dot2_f32_bf16 v221, v197, s56, v221
buffer_load_dwordx4 v5, s[12:15], s55 offen offset:1024 lds
v_dot2_f32_bf16 v223, v197, v197, v223
v_dot2_f32_bf16 v220, v198, s56, v220
v_dot2_f32_bf16 v222, v198, v198, v222
v_dot2_f32_bf16 v221, v199, s56, v221
v_dot2_f32_bf16 v223, v199, v199, v223
ds_read_b128 a[80:83], v212 offset:8192
s_add_u32 m0, s54, 65536
s_mov_b32 s55, 640
buffer_load_dwordx4 v4, s[12:15], s55 offen lds
ds_read_b128 a[84:87], v213 offset:8192
ds_read_b128 a[88:91], v214 offset:8192
ds_read_b128 a[92:95], v215 offset:8192
s_waitcnt lgkmcnt(13)
v_dot2_f32_bf16 v220, v200, s56, v220
v_dot2_f32_bf16 v222, v200, v200, v222
v_dot2_f32_bf16 v221, v201, s56, v221
buffer_load_dwordx4 v5, s[12:15], s55 offen offset:1024 lds
v_dot2_f32_bf16 v223, v201, v201, v223
v_dot2_f32_bf16 v220, v202, s56, v220
v_dot2_f32_bf16 v222, v202, v202, v222
v_dot2_f32_bf16 v221, v203, s56, v221
v_dot2_f32_bf16 v223, v203, v203, v223
s_waitcnt lgkmcnt(12)
v_dot2_f32_bf16 v220, v204, s56, v220
s_add_u32 m0, s54, 73728
s_mov_b32 s55, 768
buffer_load_dwordx4 v4, s[12:15], s55 offen lds
v_dot2_f32_bf16 v222, v204, v204, v222
v_dot2_f32_bf16 v221, v205, s56, v221
v_dot2_f32_bf16 v223, v205, v205, v223
v_dot2_f32_bf16 v220, v206, s56, v220
v_dot2_f32_bf16 v222, v206, v206, v222
v_dot2_f32_bf16 v221, v207, s56, v221
buffer_load_dwordx4 v5, s[12:15], s55 offen offset:1024 lds
v_dot2_f32_bf16 v223, v207, v207, v223
ds_read_b128 a[96:99], v212 offset:16384
ds_read_b128 a[100:103], v213 offset:16384
ds_read_b128 a[104:107], v214 offset:16384
ds_read_b128 a[108:111], v215 offset:16384
v_add_f32 v220, v220, v221
s_add_u32 m0, s54, 81920
s_nop 0
buffer_load_dwordx4 v4, s[16:19], 0 offen lds
v_add_f32 v222, v222, v223
v_and_b32 v1, 31, v0
v_mov_b32 v221, v220
v_mov_b32 v223, v222
v_lshlrev_b32 v1, 3, v1
v_permlane32_swap_b32 v220, v221
buffer_load_dwordx4 v5, s[16:19], 0 offen offset:1024 lds
v_permlane32_swap_b32 v222, v223
s_lshl_b32 s98, s3, 8
s_add_u32 s98, s98, 155648
v_add_f32 v220, v220, v221
v_add_f32 v221, v222, v223
v_add_u32 v2, s98, v1
s_add_u32 m0, s54, 90112
s_mov_b32 s55, 128
buffer_load_dwordx4 v4, s[16:19], s55 offen lds
ds_write_b64 v2, v[220:221]
s_xor_b32 s98, s3, 1
s_lshl_b32 s98, s98, 8
s_add_u32 s98, s98, 155648
v_add_u32 v2, s98, v1
s_waitcnt vmcnt(9) lgkmcnt(0)
s_barrier
buffer_load_dwordx4 v5, s[16:19], s55 offen offset:1024 lds
ds_read_b64 v[222:223], v2
ds_read_b128 v[56:59], v10 offset:24576
ds_read_b128 v[60:63], v11 offset:24576
ds_read_b128 v[64:67], v12 offset:24576
ds_read_b128 v[68:71], v13 offset:24576
ds_read_b128 v[72:75], v10 offset:32768
ds_read_b128 v[76:79], v11 offset:32768
s_waitcnt lgkmcnt(5)
v_mfma_f32_32x32x16_bf16 v[88:103], a[0:3], v[56:59], 0
ds_read_b128 v[80:83], v12 offset:32768
s_add_u32 m0, s54, 98304
s_mov_b32 s55, 256
buffer_load_dwordx4 v4, s[16:19], s55 offen lds
v_mfma_f32_16x16x32_bf16 v[240:243], a[208:211], v[56:59], 0
s_waitcnt lgkmcnt(5)
v_mfma_f32_32x32x16_bf16 v[88:103], a[4:7], v[60:63], v[88:103]
ds_read_b128 v[84:87], v13 offset:32768
s_mul_i32 s51, s5, 229376
s_add_u32 s24, s88, s51
s_addc_u32 s25, s89, 0
buffer_load_dwordx4 v5, s[16:19], s55 offen offset:1024 lds
v_add_f32 v220, v220, v222
v_mfma_f32_16x16x32_bf16 v[240:243], a[208:211], v[60:63], v[240:243]
v_add_f32 v221, v221, v223
s_waitcnt lgkmcnt(5)
v_mfma_f32_32x32x16_bf16 v[88:103], a[8:11], v[64:67], v[88:103]
ds_read_b128 v[56:59], v10 offset:40960
s_mov_b32 s26, 229376
s_mov_b32 s27, 0x20000
s_add_u32 m0, s54, 106496
s_mov_b32 s55, 384
buffer_load_dwordx4 v4, s[16:19], s55 offen lds
v_mul_f32 v220, 0x3b124925, v220
v_mfma_f32_16x16x32_bf16 v[240:243], a[208:211], v[64:67], v[240:243]
v_mul_f32 v221, 0x3b124925, v221
v_lshlrev_b32 v32, 16, v32
v_lshlrev_b32 v33, 16, v33
s_waitcnt lgkmcnt(5)
v_mfma_f32_32x32x16_bf16 v[88:103], a[12:15], v[68:71], v[88:103]
ds_read_b128 v[60:63], v11 offset:40960
s_lshl_b32 s51, s5, 7
s_add_u32 s28, s74, s51
s_addc_u32 s29, s75, 0
buffer_load_dwordx4 v5, s[16:19], s55 offen offset:1024 lds
v_cvt_pk_bf16_f32 v225, v220, v220
v_mfma_f32_16x16x32_bf16 v[240:243], a[208:211], v[68:71], v[240:243]
v_and_b32 v222, s59, v225
v_lshlrev_b32 v1, 16, v34
v_lshlrev_b32 v250, 16, v250
s_waitcnt lgkmcnt(2)
v_mfma_f32_32x32x16_bf16 v[88:103], a[16:19], v[72:75], v[88:103]
ds_read_b128 v[64:67], v12 offset:40960
s_sub_u32 s30, 401408, s51
s_mov_b32 s31, 0x20000
s_add_u32 m0, s54, 114688
s_mov_b32 s55, 512
buffer_load_dwordx4 v4, s[16:19], s55 offen lds
v_fma_f32 v221, -v220, v220, v221
v_mfma_f32_16x16x32_bf16 v[240:243], a[208:211], v[72:75], v[240:243]
v_max_f32 v221, 0, v221
v_mul_f32 v1, 0x3fb8aa3b, v1
v_lshlrev_b32 v251, 16, v251
v_mfma_f32_32x32x16_bf16 v[88:103], a[20:23], v[76:79], v[88:103]
ds_read_b128 v[68:71], v13 offset:40960
s_add_u32 s32, s76, s51
s_addc_u32 s33, s77, 0
s_sub_u32 s34, 401408, s51
buffer_load_dwordx4 v5, s[16:19], s55 offen offset:1024 lds
v_cvt_pk_bf16_f32 v225, v221, v221
v_mfma_f32_16x16x32_bf16 v[240:243], a[208:211], v[76:79], v[240:243]
v_and_b32 v223, s59, v225
v_exp_f32 v1, v1
s_nop 0
v_cvt_pk_bf16_f32 v1, v1, v1
v_mfma_f32_32x32x16_bf16 v[88:103], a[24:27], v[80:83], v[88:103]
ds_read_b128 v[72:75], v10 offset:49152
s_mov_b32 s35, 0x20000
s_mul_i32 s51, s4, 401408
v_add_f32 v223, 0x3727c5ac, v223
v_cvt_pk_bf16_f32 v225, v223, v223
v_and_b32 v1, s59, v1
v_mfma_f32_16x16x32_bf16 v[240:243], a[208:211], v[80:83], v[240:243]
v_mul_f32 v2, v1, v32
v_mfma_f32_32x32x16_bf16 v[88:103], a[28:31], v[84:87], v[88:103]
ds_read_b128 v[76:79], v11 offset:49152
s_add_u32 s51, s51, 1048576
s_add_u32 s40, s6, s51
s_addc_u32 s41, s7, 0
v_and_b32 v223, s59, v225
v_sqrt_f32 v223, v223
v_mfma_f32_16x16x32_bf16 v[240:243], a[208:211], v[84:87], v[240:243]
v_mul_f32 v3, v1, v33
v_mul_f32 v2, 0x3fb8aa3b, v2
s_waitcnt lgkmcnt(2)
v_mfma_f32_32x32x16_bf16 v[88:103], a[32:35], v[56:59], v[88:103]
ds_read_b128 v[80:83], v12 offset:49152
s_mov_b32 s42, 401408
s_mov_b32 s43, 0x20000
v_cvt_pk_bf16_f32 v225, v223, v223
v_and_b32 v223, s59, v225
v_mul_f32 v3, 0x3e22f983, v3
v_mfma_f32_16x16x32_bf16 v[240:243], a[208:211], v[56:59], v[240:243]
v_exp_f32 v2, v2
v_mfma_f32_32x32x16_bf16 v[88:103], a[36:39], v[60:63], v[88:103]
ds_read_b128 v[84:87], v13 offset:49152
s_mul_i32 s51, s4, 114688
s_add_u32 s44, s92, s51
s_addc_u32 s45, s93, 0
v_mov_b32 v227, v223
v_rcp_f32 v223, v223
v_mfma_f32_16x16x32_bf16 v[240:243], a[208:211], v[60:63], v[240:243]
v_fract_f32 v3, v3
v_cos_f32 v48, v3
v_mfma_f32_32x32x16_bf16 v[88:103], a[40:43], v[64:67], v[88:103]
s_mov_b32 s46, 114688
s_mov_b32 s47, 0x20000
v_mul_f32 v226, v221, v223
v_mul_f32 v226, v226, v223
v_sin_f32 v49, v3
v_mfma_f32_16x16x32_bf16 v[240:243], a[208:211], v[64:67], v[240:243]
v_mul_f32 v42, v32, v32
v_mfma_f32_32x32x16_bf16 v[88:103], a[44:47], v[68:71], v[88:103]
s_mul_i32 s91, s5, 57344
s_add_u32 s91, s91, s54
v_cvt_pk_bf16_f32 v225, v226, v226
v_and_b32 v226, s59, v225
v_fmac_f32 v42, v33, v33
v_mul_f32 v48, v2, v48
v_mfma_f32_16x16x32_bf16 v[240:243], a[208:211], v[68:71], v[240:243]
s_waitcnt lgkmcnt(0)
v_mfma_f32_32x32x16_bf16 v[88:103], a[48:51], v[72:75], v[88:103]
s_mov_b32 s52, s5
s_add_u32 s52, s52, 1
v_add_f32 v226, 0x3727c5ac, v226
v_cvt_pk_bf16_f32 v225, v226, v226
v_mul_f32 v49, v2, v49
v_rcp_f32 v2, v42
v_mfma_f32_16x16x32_bf16 v[240:243], a[208:211], v[72:75], v[240:243]
v_mfma_f32_32x32x16_bf16 v[88:103], a[52:55], v[76:79], v[88:103]
s_cmp_eq_u32 s52, 7
s_cselect_b32 s52, 0, s52
s_lshl_b32 s66, s52, 7
v_and_b32 v226, s59, v225
v_sqrt_f32 v226, v226
v_mfma_f32_16x16x32_bf16 v[240:243], a[208:211], v[76:79], v[240:243]
v_add_f32 v1, -1.0, v48
v_mul_f32 v42, v1, v32
s_waitcnt vmcnt(10)
s_barrier
v_mfma_f32_32x32x16_bf16 v[88:103], a[56:59], v[80:83], v[88:103]
ds_read_b128 v[56:59], v10 offset:57344
ds_read_b128 v[60:63], v11 offset:57344
s_mul_i32 s73, s52, 57344
s_lshl_b32 s50, s52, 13
s_add_u32 m0, s54, 0
s_mov_b32 s55, 640
buffer_load_dwordx4 v4, s[16:19], s55 offen lds
v_cvt_pk_bf16_f32 v225, v226, v226
v_mfma_f32_16x16x32_bf16 v[240:243], a[208:211], v[80:83], v[240:243]
v_and_b32 v226, s59, v225
v_mul_f32 v43, v49, v32
v_fmac_f32 v42, v49, v33
v_mfma_f32_32x32x16_bf16 v[88:103], a[60:63], v[84:87], v[88:103]
ds_read_b128 v[64:67], v12 offset:57344
ds_read_b128 v[68:71], v13 offset:57344
s_add_u32 s82, s50, s91
s_add_u32 s52, s52, 1
buffer_load_dwordx4 v5, s[16:19], s55 offen offset:1024 lds
v_mul_f32 v227, v227, v226
v_mfma_f32_16x16x32_bf16 v[240:243], a[208:211], v[84:87], v[240:243]
v_cvt_pk_bf16_f32 v225, v227, v227
v_fma_f32 v43, -v1, v33, v43
v_add_f32 v2, v2, v2
s_waitcnt lgkmcnt(3)
v_mfma_f32_32x32x16_bf16 v[88:103], a[64:67], v[56:59], v[88:103]
ds_read_b128 v[72:75], v14 offset:0
ds_read_b128 v[76:79], v15 offset:0
s_cmp_eq_u32 s52, 7
s_cselect_b32 s52, 0, s52
s_lshl_b32 s67, s52, 7
s_add_u32 m0, s54, 8192
s_mov_b32 s55, 768
buffer_load_dwordx4 v4, s[16:19], s55 offen lds
v_and_b32 v225, s59, v225
v_mfma_f32_16x16x32_bf16 v[240:243], a[208:211], v[56:59], v[240:243]
v_mov_b32 v32, v48
v_mov_b32 v33, v49
s_waitcnt lgkmcnt(4)
v_mfma_f32_32x32x16_bf16 v[88:103], a[68:71], v[60:63], v[88:103]
ds_read_b128 v[80:83], v16 offset:0
ds_read_b128 v[84:87], v17 offset:0
s_mul_i32 s74, s52, 57344
s_lshl_b32 s50, s52, 13
buffer_load_dwordx4 v5, s[16:19], s55 offen offset:1024 lds
v_sub_f32 v225, v227, v225
v_mfma_f32_16x16x32_bf16 v[240:243], a[208:211], v[60:63], v[240:243]
v_mul_f32 v42, v42, v2
v_mul_f32 v43, v43, v2
s_waitcnt lgkmcnt(5)
v_mfma_f32_32x32x16_bf16 v[88:103], a[72:75], v[64:67], v[88:103]
ds_read_b128 v[56:59], v14 offset:8192
s_add_u32 s83, s50, s91
s_add_u32 s52, s52, 1
s_add_u32 m0, s54, 16384
s_nop 0
buffer_load_dwordx4 v8, s[20:23], 0 offen lds
v_cvt_pk_bf16_f32 v153, v227, v225
v_mfma_f32_16x16x32_bf16 v[240:243], a[208:211], v[64:67], v[240:243]
v_mul_f32 v1, v32, v32
v_mul_f32 v2, v32, v33
s_waitcnt lgkmcnt(5)
v_mfma_f32_32x32x16_bf16 v[88:103], a[76:79], v[68:71], v[88:103]
ds_read_b128 v[60:63], v15 offset:8192
s_cmp_eq_u32 s52, 7
s_cselect_b32 s52, 0, s52
s_lshl_b32 s68, s52, 7
buffer_load_dwordx4 v9, s[20:23], 0 offen offset:1024 lds
v_cvt_pk_bf16_f32 v152, -v222, -v222
v_mfma_f32_16x16x32_bf16 v[240:243], a[208:211], v[68:71], v[240:243]
v_fma_f32 v34, -v33, v33, v1
v_add_f32 v35, v2, v2
s_waitcnt lgkmcnt(2)
v_mfma_f32_32x32x16_bf16 v[88:103], a[80:83], v[72:75], v[88:103]
ds_read_b128 v[64:67], v16 offset:8192
s_mul_i32 s75, s52, 57344
s_lshl_b32 s50, s52, 13
s_add_u32 m0, s54, 24576
s_mov_b32 s55, 229376
buffer_load_dwordx4 v8, s[20:23], s55 offen lds
v_cmp_gt_u32 vcc, 32, v0
v_mfma_f32_16x16x32_bf16 v[240:243], a[208:211], v[72:75], v[240:243]
v_mul_f32 v1, v34, v34
v_mul_f32 v2, v34, v35
v_mfma_f32_32x32x16_bf16 v[88:103], a[84:87], v[76:79], v[88:103]
ds_read_b128 v[68:71], v17 offset:8192
s_add_u32 s84, s50, s91
s_add_u32 s52, s52, 1
buffer_load_dwordx4 v9, s[20:23], s55 offen offset:1024 lds
v_mov_b32 v154, 0
v_fma_f32 v34, -v35, v35, v1
v_mfma_f32_16x16x32_bf16 v[240:243], a[208:211], v[76:79], v[240:243]
v_add_f32 v35, v2, v2
v_mfma_f32_32x32x16_bf16 v[88:103], a[88:91], v[80:83], v[88:103]
s_cmp_eq_u32 s52, 7
s_cselect_b32 s52, 0, s52
s_lshl_b32 s69, s52, 7
s_add_u32 m0, s54, 32768
s_mov_b32 s55, 458752
buffer_load_dwordx4 v8, s[20:23], s55 offen lds
v_mov_b32 v155, 0
v_mfma_f32_16x16x32_bf16 v[240:243], a[208:211], v[80:83], v[240:243]
v_mul_f32 v1, v34, v34
v_mul_f32 v2, v34, v35
v_mfma_f32_32x32x16_bf16 v[88:103], a[92:95], v[84:87], v[88:103]
s_mul_i32 s76, s52, 57344
s_lshl_b32 s50, s52, 13
buffer_load_dwordx4 v9, s[20:23], s55 offen offset:1024 lds
v_cndmask_b32 v152, 0, v152, vcc
v_fma_f32 v34, -v35, v35, v1
v_add_f32 v35, v2, v2
v_mfma_f32_16x16x32_bf16 v[240:243], a[208:211], v[84:87], v[240:243]
s_waitcnt lgkmcnt(0)
v_mfma_f32_32x32x16_bf16 v[88:103], a[96:99], v[56:59], v[88:103]
s_add_u32 s85, s50, s91
s_add_u32 s52, s52, 1
s_add_u32 m0, s54, 40960
s_mov_b32 s55, 688128
buffer_load_dwordx4 v8, s[20:23], s55 offen lds
v_cndmask_b32 v153, 0, v153, vcc
v_mfma_f32_16x16x32_bf16 v[240:243], a[208:211], v[56:59], v[240:243]
v_mul_f32 v1, v34, v34
v_mul_f32 v2, v34, v35
v_mfma_f32_32x32x16_bf16 v[88:103], a[100:103], v[60:63], v[88:103]
s_cmp_eq_u32 s52, 7
s_cselect_b32 s52, 0, s52
s_lshl_b32 s70, s52, 7
buffer_load_dwordx4 v9, s[20:23], s55 offen offset:1024 lds
v_mov_b32 v158, 0
v_fma_f32 v34, -v35, v35, v1
v_mfma_f32_16x16x32_bf16 v[240:243], a[208:211], v[60:63], v[240:243]
v_add_f32 v35, v2, v2
s_waitcnt vmcnt(14)
s_barrier
v_mfma_f32_32x32x16_bf16 v[88:103], a[104:107], v[64:67], v[88:103]
ds_read_b128 v[72:75], v14 offset:16384
ds_read_b128 v[76:79], v15 offset:16384
s_mul_i32 s77, s52, 57344
s_lshl_b32 s50, s52, 13
s_add_u32 m0, s54, 49152
s_mov_b32 s55, 917504
buffer_load_dwordx4 v8, s[20:23], s55 offen lds
v_mov_b32 v159, 0
v_mfma_f32_16x16x32_bf16 v[240:243], a[208:211], v[64:67], v[240:243]
v_mul_f32 v1, v34, v34
v_mul_f32 v2, v34, v35
v_mfma_f32_32x32x16_bf16 v[88:103], a[108:111], v[68:71], v[88:103]
ds_read_b128 v[80:83], v16 offset:16384
ds_read_b128 v[84:87], v17 offset:16384
s_add_u32 s86, s50, s91
s_add_u32 s52, s52, 1
buffer_load_dwordx4 v9, s[20:23], s55 offen offset:1024 lds
v_mov_b32 v162, 0
v_mfma_f32_16x16x32_bf16 v[240:243], a[208:211], v[68:71], v[240:243]
v_fma_f32 v36, -v35, v35, v1
v_add_f32 v37, v2, v2
s_waitcnt lgkmcnt(3)
v_mfma_f32_32x32x16_bf16 v[104:119], a[0:3], v[72:75], 0
ds_read_b128 v[56:59], v14 offset:24576
ds_read_b128 v[60:63], v15 offset:24576
s_cmp_eq_u32 s52, 7
s_cselect_b32 s52, 0, s52
s_lshl_b32 s71, s52, 7
s_add_u32 m0, s54, 57344
s_mov_b32 s55, 1146880
buffer_load_dwordx4 v8, s[20:23], s55 offen lds
v_mov_b32 v163, 0
v_mfma_f32_16x16x32_bf16 v[244:247], a[208:211], v[72:75], 0
v_mul_f32 v1, v36, v34
v_mul_f32 v2, v36, v35
s_waitcnt lgkmcnt(4)
v_mfma_f32_32x32x16_bf16 v[104:119], a[4:7], v[76:79], v[104:119]
ds_read_b128 v[64:67], v16 offset:24576
ds_read_b128 v[68:71], v17 offset:24576
s_mul_i32 s78, s52, 57344
s_lshl_b32 s50, s52, 13
buffer_load_dwordx4 v9, s[20:23], s55 offen offset:1024 lds
v_rcp_f32 v226, v226
v_mfma_f32_16x16x32_bf16 v[244:247], a[208:211], v[76:79], v[244:247]
v_fma_f32 v44, -v37, v35, v1
v_fma_f32 v45, v37, v34, v2
s_waitcnt lgkmcnt(5)
v_mfma_f32_32x32x16_bf16 v[104:119], a[8:11], v[80:83], v[104:119]
ds_read_b128 v[72:75], v14 offset:32768
s_add_u32 s87, s50, s91
s_add_u32 s52, s52, 1
s_add_u32 m0, s54, 65536
s_mov_b32 s55, 1376256
buffer_load_dwordx4 v8, s[20:23], s55 offen lds
v_mul_f32 v30, v223, v226
v_mfma_f32_16x16x32_bf16 v[244:247], a[208:211], v[80:83], v[244:247]
v_mov_b32 v40, 1.0
v_mov_b32 v41, 0
s_waitcnt lgkmcnt(5)
v_mfma_f32_32x32x16_bf16 v[104:119], a[12:15], v[84:87], v[104:119]
ds_read_b128 v[76:79], v15 offset:32768
s_cmp_eq_u32 s52, 7
s_cselect_b32 s52, 0, s52
s_lshl_b32 s72, s52, 7
buffer_load_dwordx4 v9, s[20:23], s55 offen offset:1024 lds
v_mul_f32 v31, v222, v30
v_mfma_f32_16x16x32_bf16 v[244:247], a[208:211], v[84:87], v[244:247]
v_cndmask_b32 v40, v40, v34, s[60:61]
v_cndmask_b32 v41, v41, v35, s[60:61]
s_waitcnt lgkmcnt(2)
v_mfma_f32_32x32x16_bf16 v[104:119], a[16:19], v[56:59], v[104:119]
ds_read_b128 v[80:83], v16 offset:32768
s_mul_i32 s79, s52, 57344
s_lshl_b32 s50, s52, 13
s_add_u32 m0, s54, 73728
s_mov_b32 s55, 128
buffer_load_dwordx4 v8, s[20:23], s55 offen lds
v_sub_f32 v31, 0, v31
v_mfma_f32_16x16x32_bf16 v[244:247], a[208:211], v[56:59], v[244:247]
v_cndmask_b32 v40, v40, v36, s[62:63]
v_cndmask_b32 v41, v41, v37, s[62:63]
v_mfma_f32_32x32x16_bf16 v[104:119], a[20:23], v[60:63], v[104:119]
ds_read_b128 v[84:87], v17 offset:32768
s_add_u32 s88, s50, s91
s_lshl_b32 s91, s5, 13
buffer_load_dwordx4 v9, s[20:23], s55 offen offset:1024 lds
ds_write_b32 v224, v223
v_cndmask_b32 v40, v40, v44, s[96:97]
v_mfma_f32_16x16x32_bf16 v[244:247], a[208:211], v[60:63], v[244:247]
v_cndmask_b32 v41, v41, v45, s[96:97]
v_mfma_f32_32x32x16_bf16 v[104:119], a[24:27], v[64:67], v[104:119]
ds_read_b128 v[56:59], v14 offset:40960
s_add_u32 s91, s91, s54
s_mov_b32 s52, s5
v_mul_f32 v31, 0xc0135761, v30
v_mul_f32 v1, v36, v36
v_mul_f32 v2, v36, v37
v_mfma_f32_16x16x32_bf16 v[244:247], a[208:211], v[64:67], v[244:247]
v_mfma_f32_32x32x16_bf16 v[104:119], a[28:31], v[68:71], v[104:119]
ds_read_b128 v[60:63], v15 offset:40960
s_cmp_eq_u32 s52, 0
s_cselect_b32 s52, 7, s52
s_sub_u32 s52, s52, 1
v_mul_f32 v225, v30, v30
v_fma_f32 v36, -v37, v37, v1
v_mfma_f32_16x16x32_bf16 v[244:247], a[208:211], v[68:71], v[244:247]
v_add_f32 v37, v2, v2
s_waitcnt lgkmcnt(3)
v_mfma_f32_32x32x16_bf16 v[104:119], a[32:35], v[72:75], v[104:119]
ds_read_b128 v[64:67], v16 offset:40960
s_mul_i32 s50, s52, 57344
s_add_u32 s64, s50, s91
v_mul_f32 v225, v225, v30
v_mul_f32 v1, v36, v36
v_mul_f32 v2, v36, v37
v_mfma_f32_16x16x32_bf16 v[244:247], a[208:211], v[72:75], v[244:247]
v_mfma_f32_32x32x16_bf16 v[104:119], a[36:39], v[76:79], v[104:119]
ds_read_b128 v[68:71], v17 offset:40960
s_cmp_eq_u32 s52, 0
s_cselect_b32 s52, 7, s52
s_sub_u32 s52, s52, 1
v_mul_f32 v29, 0xbdd2d3e8, v225
v_fma_f32 v38, -v37, v37, v1
v_mfma_f32_16x16x32_bf16 v[244:247], a[208:211], v[76:79], v[244:247]
v_add_f32 v39, v2, v2
v_mfma_f32_32x32x16_bf16 v[104:119], a[40:43], v[80:83], v[104:119]
s_mul_i32 s50, s52, 57344
s_add_u32 s65, s50, s91
v_mov_b32 v30, v227
v_mul_f32 v1, v38, v38
v_mul_f32 v2, v38, v39
v_mfma_f32_16x16x32_bf16 v[244:247], a[208:211], v[80:83], v[244:247]
v_mfma_f32_32x32x16_bf16 v[104:119], a[44:47], v[84:87], v[104:119]
s_cmp_eq_u32 s52, 0
s_cselect_b32 s52, 7, s52
s_sub_u32 s52, s52, 1
ds_write_b32 v224, v222 offset:256
v_fma_f32 v38, -v39, v39, v1
v_add_f32 v39, v2, v2
v_mfma_f32_16x16x32_bf16 v[244:247], a[208:211], v[84:87], v[244:247]
s_waitcnt lgkmcnt(1)
v_mfma_f32_32x32x16_bf16 v[104:119], a[48:51], v[56:59], v[104:119]
s_mul_i32 s50, s52, 57344
s_add_u32 s80, s50, s91
v_mul_f32 v1, v38, v38
v_mul_f32 v2, v38, v39
v_mfma_f32_16x16x32_bf16 v[244:247], a[208:211], v[56:59], v[244:247]
v_mfma_f32_32x32x16_bf16 v[104:119], a[52:55], v[60:63], v[104:119]
s_cmp_eq_u32 s52, 0
s_cselect_b32 s52, 7, s52
s_sub_u32 s52, s52, 1
v_fma_f32 v38, -v39, v39, v1
v_add_f32 v39, v2, v2
v_mfma_f32_16x16x32_bf16 v[244:247], a[208:211], v[60:63], v[244:247]
s_waitcnt vmcnt(16) lgkmcnt(0)
s_barrier
v_mfma_f32_32x32x16_bf16 v[104:119], a[56:59], v[64:67], v[104:119]
ds_read_b128 v[72:75], v14 offset:49152
ds_read_b128 v[76:79], v15 offset:49152
s_mul_i32 s50, s52, 57344
s_add_u32 m0, s54, 81920
s_mov_b32 s55, 229504
buffer_load_dwordx4 v8, s[20:23], s55 offen lds
v_mul_f32 v1, v38, v38
v_mfma_f32_16x16x32_bf16 v[244:247], a[208:211], v[64:67], v[244:247]
v_mul_f32 v2, v38, v39
v_mfma_f32_32x32x16_bf16 v[104:119], a[60:63], v[68:71], v[104:119]
ds_read_b128 v[80:83], v16 offset:49152
ds_read_b128 v[84:87], v17 offset:49152
s_add_u32 s81, s50, s91
buffer_load_dwordx4 v9, s[20:23], s55 offen offset:1024 lds
v_fma_f32 v38, -v39, v39, v1
v_add_f32 v39, v2, v2
v_mfma_f32_16x16x32_bf16 v[244:247], a[208:211], v[68:71], v[244:247]
s_waitcnt lgkmcnt(3)
v_mfma_f32_32x32x16_bf16 v[104:119], a[64:67], v[72:75], v[104:119]
ds_read_b128 v[56:59], v10 offset:0
ds_read_b128 v[60:63], v11 offset:0
s_cmp_eq_u32 s52, 0
s_cselect_b32 s52, 7, s52
s_add_u32 m0, s54, 90112
s_mov_b32 s55, 458880
buffer_load_dwordx4 v8, s[20:23], s55 offen lds
v_mfma_f32_16x16x32_bf16 v[244:247], a[208:211], v[72:75], v[244:247]
s_waitcnt lgkmcnt(4)
v_mfma_f32_32x32x16_bf16 v[104:119], a[68:71], v[76:79], v[104:119]
ds_read_b128 v[64:67], v12 offset:0
ds_read_b128 v[68:71], v13 offset:0
s_sub_u32 s52, s52, 1
buffer_load_dwordx4 v9, s[20:23], s55 offen offset:1024 lds
v_mfma_f32_16x16x32_bf16 v[244:247], a[208:211], v[76:79], v[244:247]
s_waitcnt lgkmcnt(5)
v_mfma_f32_32x32x16_bf16 v[104:119], a[72:75], v[80:83], v[104:119]
ds_read_b128 v[72:75], v10 offset:8192
s_mul_i32 s50, s52, 57344
s_add_u32 m0, s54, 98304
s_mov_b32 s55, 688256
buffer_load_dwordx4 v8, s[20:23], s55 offen lds
ds_read_b128 v[184:187], v26 offset:0
ds_read_b128 v[188:191], v26 offset:16
v_mfma_f32_16x16x32_bf16 v[244:247], a[208:211], v[80:83], v[244:247]
s_waitcnt lgkmcnt(7)
v_mfma_f32_32x32x16_bf16 v[104:119], a[76:79], v[84:87], v[104:119]
ds_read_b128 v[76:79], v11 offset:8192
s_add_u32 s89, s50, s91
buffer_load_dwordx4 v9, s[20:23], s55 offen offset:1024 lds
ds_read_b128 v[192:195], v26 offset:32
ds_read_b128 v[196:199], v26 offset:48
v_mfma_f32_16x16x32_bf16 v[244:247], a[208:211], v[84:87], v[244:247]
s_waitcnt lgkmcnt(6)
v_mfma_f32_32x32x16_bf16 v[104:119], a[80:83], v[56:59], v[104:119]
ds_read_b128 v[80:83], v12 offset:8192
s_cmp_eq_u32 s52, 0
s_cselect_b32 s52, 7, s52
s_add_u32 m0, s54, 106496
s_mov_b32 s55, 917632
buffer_load_dwordx4 v8, s[20:23], s55 offen lds
ds_read_b128 v[200:203], v26 offset:256
v_mfma_f32_16x16x32_bf16 v[244:247], a[208:211], v[56:59], v[244:247]
v_mfma_f32_32x32x16_bf16 v[104:119], a[84:87], v[60:63], v[104:119]
ds_read_b128 v[84:87], v13 offset:8192
s_sub_u32 s52, s52, 1
buffer_load_dwordx4 v9, s[20:23], s55 offen offset:1024 lds
ds_read_b128 v[204:207], v26 offset:272
v_mfma_f32_16x16x32_bf16 v[244:247], a[208:211], v[60:63], v[244:247]
v_mfma_f32_32x32x16_bf16 v[104:119], a[88:91], v[64:67], v[104:119]
s_mul_i32 s50, s52, 57344
ds_read_b128 v[208:211], v26 offset:288
v_mfma_f32_16x16x32_bf16 v[244:247], a[208:211], v[64:67], v[244:247]
v_mfma_f32_32x32x16_bf16 v[104:119], a[92:95], v[68:71], v[104:119]
s_add_u32 s90, s50, s91
ds_read_b128 v[212:215], v26 offset:304
v_mfma_f32_16x16x32_bf16 v[244:247], a[208:211], v[68:71], v[244:247]
s_waitcnt lgkmcnt(3)
v_mfma_f32_32x32x16_bf16 v[104:119], a[96:99], v[72:75], v[104:119]
v_mfma_f32_16x16x32_bf16 v[244:247], a[208:211], v[72:75], v[244:247]
v_mfma_f32_32x32x16_bf16 v[104:119], a[100:103], v[76:79], v[104:119]
v_mfma_f32_16x16x32_bf16 v[244:247], a[208:211], v[76:79], v[244:247]
s_waitcnt vmcnt(16)
s_barrier
v_mfma_f32_32x32x16_bf16 v[104:119], a[104:107], v[80:83], v[104:119]
ds_read_b64_tr_b16 v[56:57], v18 offset:16384
ds_read_b64_tr_b16 v[58:59], v18 offset:16896
ds_read_b64_tr_b16 v[60:61], v18 offset:18432
ds_read_b64_tr_b16 v[62:63], v18 offset:18944
s_add_u32 m0, s54, 114688
s_mov_b32 s55, 1147008
buffer_load_dwordx4 v8, s[20:23], s55 offen lds
v_mfma_f32_16x16x32_bf16 v[244:247], a[208:211], v[80:83], v[244:247]
v_mfma_f32_32x32x16_bf16 v[104:119], a[108:111], v[84:87], v[104:119]
ds_read_b64_tr_b16 v[64:65], v18 offset:20480
ds_read_b64_tr_b16 v[66:67], v18 offset:20992
ds_read_b64_tr_b16 v[68:69], v18 offset:22528
ds_read_b64_tr_b16 v[70:71], v18 offset:23040
buffer_load_dwordx4 v9, s[20:23], s55 offen offset:1024 lds
v_mfma_f32_16x16x32_bf16 v[244:247], a[208:211], v[84:87], v[244:247]
s_waitcnt lgkmcnt(6)
v_mfma_f32_32x32x16_bf16 v[120:135], v[56:59], a[0:3], 0
ds_read_b64_tr_b16 v[72:73], v18 offset:24576
ds_read_b64_tr_b16 v[74:75], v18 offset:25088
ds_read_b64_tr_b16 v[76:77], v18 offset:26624
ds_read_b64_tr_b16 v[78:79], v18 offset:27136
s_add_u32 m0, s54, 0
s_mov_b32 s55, 1376384
buffer_load_dwordx4 v8, s[20:23], s55 offen lds
s_waitcnt lgkmcnt(8)
v_mfma_f32_32x32x16_bf16 v[120:135], v[60:63], a[4:7], v[120:135]
ds_read_b64_tr_b16 v[80:81], v18 offset:28672
ds_read_b64_tr_b16 v[82:83], v18 offset:29184
ds_read_b64_tr_b16 v[84:85], v18 offset:30720
ds_read_b64_tr_b16 v[86:87], v18 offset:31232
v_fma_f32 v88, -v200, v240, v88
v_fma_f32 v104, -v200, v244, v104
v_mul_f32 v2, v42, v88
v_mul_f32 v3, v42, v104
v_fma_f32 v2, -v43, v104, v2
s_waitcnt lgkmcnt(10)
v_mfma_f32_32x32x16_bf16 v[120:135], v[64:67], a[8:11], v[120:135]
ds_read_b64_tr_b16 v[56:57], v18 offset:32768
ds_read_b64_tr_b16 v[58:59], v18 offset:33280
buffer_load_dwordx4 v9, s[20:23], s55 offen offset:1024 lds
v_fmac_f32 v3, v43, v88
v_mul_f32 v88, v2, v184
v_mul_f32 v104, v3, v184
v_fma_f32 v89, -v201, v240, v89
v_fma_f32 v105, -v201, v244, v105
s_waitcnt lgkmcnt(10)
v_mfma_f32_32x32x16_bf16 v[120:135], v[68:71], a[12:15], v[120:135]
ds_read_b64_tr_b16 v[60:61], v18 offset:34816
ds_read_b64_tr_b16 v[62:63], v18 offset:35328
s_add_u32 m0, s54, 8192
s_mov_b32 s55, 256
buffer_load_dwordx4 v8, s[20:23], s55 offen lds
v_mul_f32 v54, v42, v89
v_mul_f32 v55, v42, v105
v_fma_f32 v54, -v43, v105, v54
v_fmac_f32 v55, v43, v89
v_mul_f32 v89, v54, v185
s_waitcnt lgkmcnt(4)
v_mfma_f32_32x32x16_bf16 v[120:135], v[72:75], a[16:19], v[120:135]
ds_read_b64_tr_b16 v[64:65], v18 offset:36864
ds_read_b64_tr_b16 v[66:67], v18 offset:37376
buffer_load_dwordx4 v9, s[20:23], s55 offen offset:1024 lds
v_mul_f32 v105, v55, v185
v_fma_f32 v90, -v202, v240, v90
v_fma_f32 v106, -v202, v244, v106
v_mul_f32 v2, v42, v90
v_mul_f32 v3, v42, v106
v_mfma_f32_32x32x16_bf16 v[120:135], v[76:79], a[20:23], v[120:135]
ds_read_b64_tr_b16 v[68:69], v18 offset:38912
ds_read_b64_tr_b16 v[70:71], v18 offset:39424
v_fma_f32 v2, -v43, v106, v2
v_fmac_f32 v3, v43, v90
v_mul_f32 v90, v2, v186
v_mul_f32 v106, v3, v186
v_fma_f32 v91, -v203, v240, v91
v_mfma_f32_32x32x16_bf16 v[120:135], v[80:83], a[24:27], v[120:135]
ds_read_b64_tr_b16 v[72:73], v18 offset:40960
ds_read_b64_tr_b16 v[74:75], v18 offset:41472
v_fma_f32 v107, -v203, v244, v107
v_mul_f32 v54, v42, v91
v_mul_f32 v55, v42, v107
v_fma_f32 v54, -v43, v107, v54
v_fmac_f32 v55, v43, v91
v_mfma_f32_32x32x16_bf16 v[120:135], v[84:87], a[28:31], v[120:135]
ds_read_b64_tr_b16 v[76:77], v18 offset:43008
ds_read_b64_tr_b16 v[78:79], v18 offset:43520
v_mul_f32 v91, v54, v187
v_mul_f32 v107, v55, v187
v_fma_f32 v92, -v204, v240, v92
v_fma_f32 v108, -v204, v244, v108
v_mul_f32 v2, v42, v92
s_waitcnt lgkmcnt(4)
v_mfma_f32_32x32x16_bf16 v[120:135], v[56:59], a[32:35], v[120:135]
ds_read_b64_tr_b16 v[80:81], v18 offset:45056
ds_read_b64_tr_b16 v[82:83], v18 offset:45568
v_mul_f32 v3, v42, v108
v_fma_f32 v2, -v43, v108, v2
v_fmac_f32 v3, v43, v92
v_mul_f32 v92, v2, v188
v_mul_f32 v108, v3, v188
v_mfma_f32_32x32x16_bf16 v[120:135], v[60:63], a[36:39], v[120:135]
ds_read_b64_tr_b16 v[84:85], v18 offset:47104
ds_read_b64_tr_b16 v[86:87], v18 offset:47616
v_fma_f32 v93, -v205, v240, v93
v_fma_f32 v109, -v205, v244, v109
v_mul_f32 v54, v42, v93
v_mul_f32 v55, v42, v109
v_fma_f32 v54, -v43, v109, v54
v_mfma_f32_32x32x16_bf16 v[120:135], v[64:67], a[40:43], v[120:135]
v_fmac_f32 v55, v43, v93
v_mul_f32 v93, v54, v189
v_mul_f32 v109, v55, v189
v_fma_f32 v94, -v206, v240, v94
v_fma_f32 v110, -v206, v244, v110
v_mfma_f32_32x32x16_bf16 v[120:135], v[68:71], a[44:47], v[120:135]
v_mul_f32 v2, v42, v94
v_mul_f32 v3, v42, v110
v_fma_f32 v2, -v43, v110, v2
v_fmac_f32 v3, v43, v94
v_mul_f32 v94, v2, v190
s_waitcnt lgkmcnt(0)
v_mfma_f32_32x32x16_bf16 v[120:135], v[72:75], a[48:51], v[120:135]
v_mul_f32 v110, v3, v190
v_fma_f32 v95, -v207, v240, v95
v_fma_f32 v111, -v207, v244, v111
v_mul_f32 v54, v42, v95
v_mul_f32 v55, v42, v111
v_mfma_f32_32x32x16_bf16 v[120:135], v[76:79], a[52:55], v[120:135]
v_fma_f32 v54, -v43, v111, v54
v_fmac_f32 v55, v43, v95
v_mul_f32 v95, v54, v191
v_mul_f32 v111, v55, v191
v_fma_f32 v96, -v208, v240, v96
s_waitcnt vmcnt(16)
s_barrier
v_mfma_f32_32x32x16_bf16 v[120:135], v[80:83], a[56:59], v[120:135]
ds_read_b64_tr_b16 v[56:57], v18 offset:49152
ds_read_b64_tr_b16 v[58:59], v18 offset:49664
ds_read_b64_tr_b16 v[60:61], v18 offset:51200
ds_read_b64_tr_b16 v[62:63], v18 offset:51712
s_add_u32 m0, s54, 16384
s_mov_b32 s55, 229632
buffer_load_dwordx4 v8, s[20:23], s55 offen lds
v_fma_f32 v112, -v208, v244, v112
v_mul_f32 v2, v42, v96
v_mul_f32 v3, v42, v112
v_fma_f32 v2, -v43, v112, v2
v_fmac_f32 v3, v43, v96
v_mfma_f32_32x32x16_bf16 v[120:135], v[84:87], a[60:63], v[120:135]
ds_read_b64_tr_b16 v[64:65], v18 offset:53248
ds_read_b64_tr_b16 v[66:67], v18 offset:53760
ds_read_b64_tr_b16 v[68:69], v18 offset:55296
ds_read_b64_tr_b16 v[70:71], v18 offset:55808
buffer_load_dwordx4 v9, s[20:23], s55 offen offset:1024 lds
v_mul_f32 v96, v2, v192
v_mul_f32 v112, v3, v192
v_fma_f32 v97, -v209, v240, v97
v_fma_f32 v113, -v209, v244, v113
v_mul_f32 v54, v42, v97
s_waitcnt lgkmcnt(6)
v_mfma_f32_32x32x16_bf16 v[120:135], v[56:59], a[64:67], v[120:135]
ds_read_b64_tr_b16 v[72:73], v18 offset:57344
ds_read_b64_tr_b16 v[74:75], v18 offset:57856
ds_read_b64_tr_b16 v[76:77], v18 offset:59392
ds_read_b64_tr_b16 v[78:79], v18 offset:59904
s_add_u32 m0, s54, 24576
s_mov_b32 s55, 459008
buffer_load_dwordx4 v8, s[20:23], s55 offen lds
v_mul_f32 v55, v42, v113
v_fma_f32 v54, -v43, v113, v54
v_fmac_f32 v55, v43, v97
v_mul_f32 v97, v54, v193
v_mul_f32 v113, v55, v193
s_waitcnt lgkmcnt(8)
v_mfma_f32_32x32x16_bf16 v[120:135], v[60:63], a[68:71], v[120:135]
ds_read_b64_tr_b16 v[80:81], v18 offset:61440
ds_read_b64_tr_b16 v[82:83], v18 offset:61952
ds_read_b64_tr_b16 v[84:85], v18 offset:63488
ds_read_b64_tr_b16 v[86:87], v18 offset:64000
buffer_load_dwordx4 v9, s[20:23], s55 offen offset:1024 lds
v_fma_f32 v98, -v210, v240, v98
v_fma_f32 v114, -v210, v244, v114
v_mul_f32 v2, v42, v98
v_mul_f32 v3, v42, v114
v_fma_f32 v2, -v43, v114, v2
s_waitcnt lgkmcnt(10)
v_mfma_f32_32x32x16_bf16 v[120:135], v[64:67], a[72:75], v[120:135]
ds_read_b64_tr_b16 v[56:57], v19 offset:0
ds_read_b64_tr_b16 v[58:59], v19 offset:512
v_mov_b32 v47, 128
global_load_dword v46, v47, s[94:95] sc1
s_add_u32 m0, s54, 32768
s_mov_b32 s55, 688384
buffer_load_dwordx4 v8, s[20:23], s55 offen lds
v_fmac_f32 v3, v43, v98
v_mul_f32 v98, v2, v194
v_mul_f32 v114, v3, v194
v_fma_f32 v99, -v211, v240, v99
v_fma_f32 v115, -v211, v244, v115
s_waitcnt lgkmcnt(10)
v_mfma_f32_32x32x16_bf16 v[120:135], v[68:71], a[76:79], v[120:135]
ds_read_b64_tr_b16 v[60:61], v19 offset:2048
ds_read_b64_tr_b16 v[62:63], v19 offset:2560
buffer_load_dwordx4 v9, s[20:23], s55 offen offset:1024 lds
v_mul_f32 v54, v42, v99
v_mul_f32 v55, v42, v115
v_fma_f32 v54, -v43, v115, v54
v_fmac_f32 v55, v43, v99
v_mul_f32 v99, v54, v195
s_waitcnt lgkmcnt(4)
v_mfma_f32_32x32x16_bf16 v[120:135], v[72:75], a[80:83], v[120:135]
ds_read_b64_tr_b16 v[64:65], v19 offset:4096
ds_read_b64_tr_b16 v[66:67], v19 offset:4608
s_add_u32 m0, s54, 40960
s_mov_b32 s55, 917760
buffer_load_dwordx4 v8, s[20:23], s55 offen lds
v_mul_f32 v115, v55, v195
v_fma_f32 v100, -v212, v240, v100
v_fma_f32 v116, -v212, v244, v116
v_mul_f32 v2, v42, v100
v_mul_f32 v3, v42, v116
v_mfma_f32_32x32x16_bf16 v[120:135], v[76:79], a[84:87], v[120:135]
ds_read_b64_tr_b16 v[68:69], v19 offset:6144
ds_read_b64_tr_b16 v[70:71], v19 offset:6656
buffer_load_dwordx4 v9, s[20:23], s55 offen offset:1024 lds
v_fma_f32 v2, -v43, v116, v2
v_fmac_f32 v3, v43, v100
v_mul_f32 v100, v2, v196
v_mul_f32 v116, v3, v196
v_fma_f32 v101, -v213, v240, v101
v_mfma_f32_32x32x16_bf16 v[120:135], v[80:83], a[88:91], v[120:135]
v_fma_f32 v117, -v213, v244, v117
v_mul_f32 v54, v42, v101
v_mul_f32 v55, v42, v117
v_fma_f32 v54, -v43, v117, v54
v_fmac_f32 v55, v43, v101
v_mfma_f32_32x32x16_bf16 v[120:135], v[84:87], a[92:95], v[120:135]
v_mul_f32 v101, v54, v197
v_mul_f32 v117, v55, v197
v_fma_f32 v102, -v214, v240, v102
v_fma_f32 v118, -v214, v244, v118
v_mul_f32 v2, v42, v102
s_waitcnt lgkmcnt(0)
v_mfma_f32_32x32x16_bf16 v[120:135], v[56:59], a[96:99], v[120:135]
v_mul_f32 v3, v42, v118
v_fma_f32 v2, -v43, v118, v2
v_fmac_f32 v3, v43, v102
v_mul_f32 v102, v2, v198
v_mul_f32 v118, v3, v198
v_mfma_f32_32x32x16_bf16 v[120:135], v[60:63], a[100:103], v[120:135]
v_fma_f32 v103, -v215, v240, v103
v_fma_f32 v119, -v215, v244, v119
v_mul_f32 v54, v42, v103
v_mul_f32 v55, v42, v119
v_fma_f32 v54, -v43, v119, v54
s_waitcnt vmcnt(17)
s_barrier
v_mfma_f32_32x32x16_bf16 v[120:135], v[64:67], a[104:107], v[120:135]
ds_read_b64_tr_b16 v[72:73], v19 offset:8192
ds_read_b64_tr_b16 v[74:75], v19 offset:8704
ds_read_b64_tr_b16 v[76:77], v19 offset:10240
ds_read_b64_tr_b16 v[78:79], v19 offset:10752
s_add_u32 m0, s54, 49152
s_mov_b32 s55, 1147136
buffer_load_dwordx4 v8, s[20:23], s55 offen lds
v_fmac_f32 v55, v43, v103
v_mul_f32 v103, v54, v199
v_mul_f32 v119, v55, v199
v_fma_f32 v50, v32, v88, v89
v_fma_f32 v51, v32, v104, v105
v_mfma_f32_32x32x16_bf16 v[120:135], v[68:71], a[108:111], v[120:135]
ds_read_b64_tr_b16 v[80:81], v19 offset:12288
ds_read_b64_tr_b16 v[82:83], v19 offset:12800
ds_read_b64_tr_b16 v[84:85], v19 offset:14336
ds_read_b64_tr_b16 v[86:87], v19 offset:14848
buffer_load_dwordx4 v9, s[20:23], s55 offen offset:1024 lds
v_fma_f32 v50, -v33, v104, v50
v_fmac_f32 v51, v33, v88
v_fma_f32 v52, v32, v50, v90
v_fma_f32 v53, v32, v51, v106
v_fma_f32 v52, -v33, v51, v52
s_waitcnt lgkmcnt(6)
v_mfma_f32_32x32x16_bf16 v[136:151], v[72:75], a[0:3], 0
ds_read_b64_tr_b16 v[56:57], v19 offset:16384
ds_read_b64_tr_b16 v[58:59], v19 offset:16896
ds_read_b64_tr_b16 v[60:61], v19 offset:18432
ds_read_b64_tr_b16 v[62:63], v19 offset:18944
s_add_u32 m0, s54, 57344
s_mov_b32 s55, 1376512
buffer_load_dwordx4 v8, s[20:23], s55 offen lds
v_fmac_f32 v53, v33, v50
v_fma_f32 v50, v32, v52, v91
v_fma_f32 v51, v32, v53, v107
v_fma_f32 v50, -v33, v53, v50
v_fmac_f32 v51, v33, v52
s_waitcnt lgkmcnt(8)
v_mfma_f32_32x32x16_bf16 v[136:151], v[76:79], a[4:7], v[136:151]
ds_read_b64_tr_b16 v[64:65], v19 offset:20480
ds_read_b64_tr_b16 v[66:67], v19 offset:20992
ds_read_b64_tr_b16 v[68:69], v19 offset:22528
ds_read_b64_tr_b16 v[70:71], v19 offset:23040
buffer_load_dwordx4 v9, s[20:23], s55 offen offset:1024 lds
v_fma_f32 v52, v32, v50, v92
v_fma_f32 v53, v32, v51, v108
v_fma_f32 v52, -v33, v51, v52
v_fmac_f32 v53, v33, v50
v_fma_f32 v50, v32, v52, v93
s_waitcnt lgkmcnt(10)
v_mfma_f32_32x32x16_bf16 v[136:151], v[80:83], a[8:11], v[136:151]
ds_read_b64_tr_b16 v[72:73], v19 offset:24576
ds_read_b64_tr_b16 v[74:75], v19 offset:25088
s_add_u32 m0, s54, 65536
s_mov_b32 s55, 384
buffer_load_dwordx4 v8, s[20:23], s55 offen lds
v_fma_f32 v51, v32, v53, v109
v_fma_f32 v50, -v33, v53, v50
v_fmac_f32 v51, v33, v52
v_fma_f32 v52, v32, v50, v94
v_fma_f32 v53, v32, v51, v110
s_waitcnt lgkmcnt(10)
v_mfma_f32_32x32x16_bf16 v[136:151], v[84:87], a[12:15], v[136:151]
ds_read_b64_tr_b16 v[76:77], v19 offset:26624
ds_read_b64_tr_b16 v[78:79], v19 offset:27136
buffer_load_dwordx4 v9, s[20:23], s55 offen offset:1024 lds
v_fma_f32 v52, -v33, v51, v52
v_fmac_f32 v53, v33, v50
v_fma_f32 v50, v32, v52, v95
v_fma_f32 v51, v32, v53, v111
v_fma_f32 v50, -v33, v53, v50
s_waitcnt lgkmcnt(4)
v_mfma_f32_32x32x16_bf16 v[136:151], v[56:59], a[16:19], v[136:151]
ds_read_b64_tr_b16 v[80:81], v19 offset:28672
ds_read_b64_tr_b16 v[82:83], v19 offset:29184
s_waitcnt vmcnt(10)
v_readfirstlane_b32 s98, v46
s_cmp_ge_u32 s98, 32
s_cbranch_scc1 L_sok1
s_mov_b32 s99, 0
L_spin1:
global_load_dword v46, v47, s[94:95] sc1
s_waitcnt vmcnt(0)
v_readfirstlane_b32 s98, v46
s_cmp_ge_u32 s98, 32
s_cbranch_scc1 L_sok1
s_add_u32 s99, s99, 1
s_cmp_gt_u32 s99, 400000
s_cbranch_scc1 L_sok1
s_sleep 12
s_branch L_spin1
L_sok1:
s_lshl_b32 s99, s3, 8
s_lshl_b32 s98, s5, 10
s_add_u32 s98, s98, s99
s_add_u32 s98, s98, 262144
v_lshlrev_b32 v48, 2, v0
v_add_u32 v49, s98, v48
global_load_dword v49, v49, s[6:7] sc1
v_fmac_f32 v51, v33, v52
v_fma_f32 v52, v32, v50, v96
v_fma_f32 v53, v32, v51, v112
v_fma_f32 v52, -v33, v51, v52
v_fmac_f32 v53, v33, v50
v_mfma_f32_32x32x16_bf16 v[136:151], v[60:63], a[20:23], v[136:151]
ds_read_b64_tr_b16 v[84:85], v19 offset:30720
ds_read_b64_tr_b16 v[86:87], v19 offset:31232
v_fma_f32 v50, v32, v52, v97
v_fma_f32 v51, v32, v53, v113
v_fma_f32 v50, -v33, v53, v50
v_fmac_f32 v51, v33, v52
v_fma_f32 v52, v32, v50, v98
v_mfma_f32_32x32x16_bf16 v[136:151], v[64:67], a[24:27], v[136:151]
ds_read_b64_tr_b16 v[56:57], v19 offset:32768
ds_read_b64_tr_b16 v[58:59], v19 offset:33280
v_fma_f32 v53, v32, v51, v114
v_fma_f32 v52, -v33, v51, v52
v_fmac_f32 v53, v33, v50
v_fma_f32 v50, v32, v52, v99
v_mfma_f32_32x32x16_bf16 v[136:151], v[68:71], a[28:31], v[136:151]
ds_read_b64_tr_b16 v[60:61], v19 offset:34816
ds_read_b64_tr_b16 v[62:63], v19 offset:35328
v_fma_f32 v51, v32, v53, v115
v_fma_f32 v50, -v33, v53, v50
v_fmac_f32 v51, v33, v52
v_fma_f32 v52, v32, v50, v100
s_waitcnt lgkmcnt(4)
v_mfma_f32_32x32x16_bf16 v[136:151], v[72:75], a[32:35], v[136:151]
ds_read_b64_tr_b16 v[64:65], v19 offset:36864
ds_read_b64_tr_b16 v[66:67], v19 offset:37376
v_fma_f32 v53, v32, v51, v116
v_fma_f32 v52, -v33, v51, v52
v_fmac_f32 v53, v33, v50
v_fma_f32 v50, v32, v52, v101
v_mfma_f32_32x32x16_bf16 v[136:151], v[76:79], a[36:39], v[136:151]
ds_read_b64_tr_b16 v[68:69], v19 offset:38912
ds_read_b64_tr_b16 v[70:71], v19 offset:39424
v_fma_f32 v51, v32, v53, v117
v_fma_f32 v50, -v33, v53, v50
v_fmac_f32 v51, v33, v52
v_fma_f32 v52, v32, v50, v102
v_mfma_f32_32x32x16_bf16 v[136:151], v[80:83], a[40:43], v[136:151]
v_fma_f32 v53, v32, v51, v118
v_fma_f32 v52, -v33, v51, v52
v_fmac_f32 v53, v33, v50
v_fma_f32 v50, v32, v52, v103
v_mfma_f32_32x32x16_bf16 v[136:151], v[84:87], a[44:47], v[136:151]
v_fma_f32 v51, v32, v53, v119
v_fma_f32 v50, -v33, v53, v50
v_fmac_f32 v51, v33, v52
s_waitcnt lgkmcnt(0)
v_mfma_f32_32x32x16_bf16 v[136:151], v[56:59], a[48:51], v[136:151]
s_lshl_b32 s98, s48, 9
v_lshrrev_b32 v1, 5, v0
v_lshl_add_u32 v1, v1, 8, v28
v_add_u32 v1, s98, v1
ds_write_b64 v1, v[50:51]
v_mfma_f32_32x32x16_bf16 v[136:151], v[60:63], a[52:55], v[136:151]
s_waitcnt lgkmcnt(0)
s_barrier
ds_read_b64 v[200:201], v28 offset:0
ds_read_b64 v[202:203], v28 offset:256
ds_read_b64 v[204:205], v28 offset:512
ds_read_b64 v[206:207], v28 offset:768
v_mfma_f32_32x32x16_bf16 v[136:151], v[64:67], a[56:59], v[136:151]
ds_read_b64_tr_b16 v[72:73], v19 offset:40960
ds_read_b64_tr_b16 v[74:75], v19 offset:41472
ds_read_b64_tr_b16 v[76:77], v19 offset:43008
ds_read_b64_tr_b16 v[78:79], v19 offset:43520
s_add_u32 m0, s54, 73728
s_mov_b32 s55, 229760
buffer_load_dwordx4 v8, s[20:23], s55 offen lds
v_mfma_f32_32x32x16_bf16 v[136:151], v[68:71], a[60:63], v[136:151]
ds_read_b64_tr_b16 v[80:81], v19 offset:45056
ds_read_b64_tr_b16 v[82:83], v19 offset:45568
ds_read_b64_tr_b16 v[84:85], v19 offset:47104
ds_read_b64_tr_b16 v[86:87], v19 offset:47616
s_waitcnt lgkmcnt(6)
v_mfma_f32_32x32x16_bf16 v[136:151], v[72:75], a[64:67], v[136:151]
ds_read_b64_tr_b16 v[56:57], v19 offset:49152
ds_read_b64_tr_b16 v[58:59], v19 offset:49664
ds_read_b64_tr_b16 v[60:61], v19 offset:51200
ds_read_b64_tr_b16 v[62:63], v19 offset:51712
buffer_load_dwordx4 v9, s[20:23], s55 offen offset:1024 lds
v_fma_f32 v208, v200, v34, v202
v_fma_f32 v209, v200, v35, v203
v_fma_f32 v208, -v201, v35, v208
v_fmac_f32 v209, v201, v34
v_fma_f32 v210, v208, v34, v204
s_waitcnt lgkmcnt(8)
v_mfma_f32_32x32x16_bf16 v[136:151], v[76:79], a[68:71], v[136:151]
ds_read_b64_tr_b16 v[64:65], v19 offset:53248
ds_read_b64_tr_b16 v[66:67], v19 offset:53760
ds_read_b64_tr_b16 v[68:69], v19 offset:55296
ds_read_b64_tr_b16 v[70:71], v19 offset:55808
s_add_u32 m0, s54, 81920
s_mov_b32 s55, 459136
buffer_load_dwordx4 v8, s[20:23], s55 offen lds
v_fma_f32 v211, v208, v35, v205
v_fma_f32 v210, -v209, v35, v210
v_fmac_f32 v211, v209, v34
v_fma_f32 v212, v210, v34, v206
v_fma_f32 v213, v210, v35, v207
s_waitcnt lgkmcnt(10)
v_mfma_f32_32x32x16_bf16 v[136:151], v[80:83], a[72:75], v[136:151]
ds_read_b64_tr_b16 v[72:73], v18 offset:0
ds_read_b64_tr_b16 v[74:75], v18 offset:512
buffer_load_dwordx4 v9, s[20:23], s55 offen offset:1024 lds
v_fma_f32 v212, -v211, v35, v212
v_fmac_f32 v213, v211, v34
v_and_b32 v1, 31, v0
v_mov_b32 v44, 0
v_mov_b32 v45, 0
s_waitcnt lgkmcnt(10)
v_mfma_f32_32x32x16_bf16 v[136:151], v[84:87], a[76:79], v[136:151]
ds_read_b64_tr_b16 v[76:77], v18 offset:2048
ds_read_b64_tr_b16 v[78:79], v18 offset:2560
s_add_u32 m0, s54, 90112
s_mov_b32 s55, 688512
buffer_load_dwordx4 v8, s[20:23], s55 offen lds
v_lshlrev_b32 v1, 3, v1
s_waitcnt lgkmcnt(4)
v_mfma_f32_32x32x16_bf16 v[136:151], v[56:59], a[80:83], v[136:151]
ds_read_b64_tr_b16 v[80:81], v18 offset:4096
ds_read_b64_tr_b16 v[82:83], v18 offset:4608
s_lshl_b32 s98, s48, 16
v_add_u32 v1, s98, v1
v_mfma_f32_32x32x16_bf16 v[136:151], v[60:63], a[84:87], v[136:151]
ds_read_b64_tr_b16 v[84:85], v18 offset:6144
ds_read_b64_tr_b16 v[86:87], v18 offset:6656
buffer_load_dwordx4 v9, s[20:23], s55 offen offset:1024 lds
s_sub_u32 s98, 31, s4
s_lshl_b32 s98, s98, 8
buffer_store_dwordx2 v[212:213], v1, s[36:39], s98 offen sc1
v_cndmask_b32 v44, v44, v200, s[60:61]
v_cndmask_b32 v45, v45, v201, s[60:61]
v_cndmask_b32 v44, v44, v208, s[62:63]
v_cndmask_b32 v45, v45, v209, s[62:63]
v_cndmask_b32 v44, v44, v210, s[96:97]
v_cndmask_b32 v45, v45, v211, s[96:97]
v_mfma_f32_32x32x16_bf16 v[136:151], v[64:67], a[88:91], v[136:151]
s_add_u32 m0, s54, 98304
s_mov_b32 s55, 917888
buffer_load_dwordx4 v8, s[20:23], s55 offen lds
v_mfma_f32_32x32x16_bf16 v[136:151], v[68:71], a[92:95], v[136:151]
s_waitcnt lgkmcnt(0)
v_mfma_f32_32x32x16_bf16 v[136:151], v[72:75], a[96:99], v[136:151]
s_waitcnt vmcnt(8)
v_cvt_pk_bf16_f32 v2, v49, v49
v_lshl_or_b32 v3, v249, 16, v249
v_and_b32 v2, s59, v2
s_lshl_b32 s98, s3, 9
v_sub_f32 v2, v49, v2
s_add_u32 s98, s98, 160256
v_cvt_pk_bf16_f32 v2, v49, v2
v_lshl_add_u32 v48, v48, 1, s98
ds_write_b64 v48, v[2:3]
buffer_load_dwordx4 v9, s[20:23], s55 offen offset:1024 lds
v_mfma_f32_32x32x16_bf16 v[136:151], v[76:79], a[100:103], v[136:151]
s_waitcnt lgkmcnt(0)
s_barrier
ds_read_b64 v[156:157], v27 offset:0
ds_read_b64 v[160:161], v27 offset:512
v_mfma_f32_32x32x16_bf16 v[136:151], v[80:83], a[104:107], v[136:151]
ds_read_b64_tr_b16 v[56:57], v18 offset:8192
ds_read_b64_tr_b16 v[58:59], v18 offset:8704
ds_read_b64_tr_b16 v[60:61], v18 offset:10240
ds_read_b64_tr_b16 v[62:63], v18 offset:10752
s_add_u32 m0, s54, 106496
s_mov_b32 s55, 1147264
buffer_load_dwordx4 v8, s[20:23], s55 offen lds
v_mfma_f32_32x32x16_bf16 v[136:151], v[84:87], a[108:111], v[136:151]
ds_read_b64_tr_b16 v[64:65], v18 offset:12288
ds_read_b64_tr_b16 v[66:67], v18 offset:12800
ds_read_b64_tr_b16 v[68:69], v18 offset:14336
ds_read_b64_tr_b16 v[70:71], v18 offset:14848
s_waitcnt lgkmcnt(6)
v_mfma_f32_32x32x16_bf16 v[216:231], v[56:59], a[0:3], 0
ds_read_b64_tr_b16 v[72:73], v18 offset:16384
ds_read_b64_tr_b16 v[74:75], v18 offset:16896
ds_read_b64_tr_b16 v[76:77], v18 offset:18432
ds_read_b64_tr_b16 v[78:79], v18 offset:18944
buffer_load_dwordx4 v9, s[20:23], s55 offen offset:1024 lds
v_mfma_f32_32x32x16_bf16 v[120:135], v[156:159], v[152:155], v[120:135]
s_waitcnt lgkmcnt(8)
v_mfma_f32_32x32x16_bf16 v[216:231], v[60:63], a[4:7], v[216:231]
ds_read_b64_tr_b16 v[80:81], v18 offset:20480
ds_read_b64_tr_b16 v[82:83], v18 offset:20992
ds_read_b64_tr_b16 v[84:85], v18 offset:22528
ds_read_b64_tr_b16 v[86:87], v18 offset:23040
s_add_u32 m0, s54, 114688
s_mov_b32 s55, 1376640
buffer_load_dwordx4 v8, s[20:23], s55 offen lds
v_mfma_f32_32x32x16_bf16 v[136:151], v[160:163], v[152:155], v[136:151]
s_waitcnt lgkmcnt(10)
v_mfma_f32_32x32x16_bf16 v[216:231], v[64:67], a[8:11], v[216:231]
ds_read_b64_tr_b16 v[56:57], v18 offset:24576
ds_read_b64_tr_b16 v[58:59], v18 offset:25088
buffer_load_dwordx4 v9, s[20:23], s55 offen offset:1024 lds
s_waitcnt lgkmcnt(10)
v_mfma_f32_32x32x16_bf16 v[216:231], v[68:71], a[12:15], v[216:231]
ds_read_b64_tr_b16 v[60:61], v18 offset:26624
ds_read_b64_tr_b16 v[62:63], v18 offset:27136
v_mul_f32 v168, v120, v120
v_mul_f32 v169, v121, v121
v_mul_f32 v170, v122, v122
v_mul_f32 v171, v123, v123
v_fma_f32 v168, v168, v29, v31
v_fma_f32 v169, v169, v29, v31
s_waitcnt lgkmcnt(4)
v_mfma_f32_32x32x16_bf16 v[216:231], v[72:75], a[16:19], v[216:231]
ds_read_b64_tr_b16 v[64:65], v18 offset:28672
ds_read_b64_tr_b16 v[66:67], v18 offset:29184
s_add_u32 m0, s54, 0
s_add_u32 s55, s66, 0
buffer_load_dwordx4 v6, s[24:27], s55 offen lds
v_fma_f32 v170, v170, v29, v31
v_fma_f32 v171, v171, v29, v31
v_mul_f32 v168, v168, v120
v_mul_f32 v169, v169, v121
v_mul_f32 v170, v170, v122
v_mul_f32 v171, v171, v123
v_mfma_f32_32x32x16_bf16 v[216:231], v[76:79], a[20:23], v[216:231]
ds_read_b64_tr_b16 v[68:69], v18 offset:30720
ds_read_b64_tr_b16 v[70:71], v18 offset:31232
buffer_load_dwordx4 v7, s[24:27], s55 offen offset:1024 lds
v_exp_f32 v168, v168
v_exp_f32 v169, v169
v_exp_f32 v170, v170
v_exp_f32 v171, v171
v_fma_f32 v168, v168, v30, v30
v_fma_f32 v169, v169, v30, v30
v_mfma_f32_32x32x16_bf16 v[216:231], v[80:83], a[24:27], v[216:231]
ds_read_b64_tr_b16 v[72:73], v18 offset:32768
ds_read_b64_tr_b16 v[74:75], v18 offset:33280
v_fma_f32 v170, v170, v30, v30
v_fma_f32 v171, v171, v30, v30
v_rcp_f32 v168, v168
v_rcp_f32 v169, v169
v_rcp_f32 v170, v170
v_rcp_f32 v171, v171
v_mfma_f32_32x32x16_bf16 v[216:231], v[84:87], a[28:31], v[216:231]
ds_read_b64_tr_b16 v[76:77], v18 offset:34816
ds_read_b64_tr_b16 v[78:79], v18 offset:35328
v_mul_f32 v120, v120, v168
v_mul_f32 v121, v121, v169
v_mul_f32 v122, v122, v170
v_mul_f32 v123, v123, v171
v_cvt_pk_bf16_f32 v176, v120, v121
v_cvt_pk_bf16_f32 v177, v122, v123
s_waitcnt lgkmcnt(4)
v_mfma_f32_32x32x16_bf16 v[216:231], v[56:59], a[32:35], v[216:231]
ds_read_b64_tr_b16 v[80:81], v18 offset:36864
ds_read_b64_tr_b16 v[82:83], v18 offset:37376
s_waitcnt vmcnt(8)
s_nop 0
s_cmp_lg_u32 s48, 0
s_cbranch_scc1 L_ow2
s_lshl_b32 s98, s5, 1
s_add_u32 s98, s98, s49
s_lshl_b32 s98, s98, 8
v_mov_b32 v47, s98
s_mov_b64 exec, 1
v_mov_b32 v1, 1
global_atomic_add v47, v1, s[6:7] sc1
s_mov_b64 exec, -1
L_ow2:
v_mul_f32 v168, v124, v124
v_mul_f32 v169, v125, v125
v_mul_f32 v170, v126, v126
v_mul_f32 v171, v127, v127
v_fma_f32 v168, v168, v29, v31
v_fma_f32 v169, v169, v29, v31
v_mfma_f32_32x32x16_bf16 v[216:231], v[60:63], a[36:39], v[216:231]
ds_read_b64_tr_b16 v[84:85], v18 offset:38912
ds_read_b64_tr_b16 v[86:87], v18 offset:39424
v_fma_f32 v170, v170, v29, v31
v_fma_f32 v171, v171, v29, v31
v_mul_f32 v168, v168, v124
v_mul_f32 v169, v169, v125
v_mul_f32 v170, v170, v126
v_mul_f32 v171, v171, v127
v_mfma_f32_32x32x16_bf16 v[216:231], v[64:67], a[40:43], v[216:231]
ds_read_b64_tr_b16 v[56:57], v18 offset:40960
ds_read_b64_tr_b16 v[58:59], v18 offset:41472
v_exp_f32 v168, v168
v_exp_f32 v169, v169
v_exp_f32 v170, v170
v_exp_f32 v171, v171
v_fma_f32 v168, v168, v30, v30
v_fma_f32 v169, v169, v30, v30
v_mfma_f32_32x32x16_bf16 v[216:231], v[68:71], a[44:47], v[216:231]
ds_read_b64_tr_b16 v[60:61], v18 offset:43008
ds_read_b64_tr_b16 v[62:63], v18 offset:43520
v_fma_f32 v170, v170, v30, v30
v_fma_f32 v171, v171, v30, v30
v_rcp_f32 v168, v168
v_rcp_f32 v169, v169
v_rcp_f32 v170, v170
v_rcp_f32 v171, v171
s_waitcnt lgkmcnt(4)
v_mfma_f32_32x32x16_bf16 v[216:231], v[72:75], a[48:51], v[216:231]
ds_read_b64_tr_b16 v[64:65], v18 offset:45056
ds_read_b64_tr_b16 v[66:67], v18 offset:45568
v_mul_f32 v124, v124, v168
v_mul_f32 v125, v125, v169
v_mul_f32 v126, v126, v170
v_mul_f32 v127, v127, v171
v_cvt_pk_bf16_f32 v178, v124, v125
v_cvt_pk_bf16_f32 v179, v126, v127
v_mfma_f32_32x32x16_bf16 v[216:231], v[76:79], a[52:55], v[216:231]
ds_read_b64_tr_b16 v[68:69], v18 offset:47104
ds_read_b64_tr_b16 v[70:71], v18 offset:47616
ds_write_b128 v22, v[176:179] offset:0
v_mul_f32 v168, v128, v128
v_mul_f32 v169, v129, v129
v_mul_f32 v170, v130, v130
v_mul_f32 v171, v131, v131
v_fma_f32 v168, v168, v29, v31
v_mfma_f32_32x32x16_bf16 v[216:231], v[80:83], a[56:59], v[216:231]
ds_read_b64_tr_b16 v[72:73], v18 offset:49152
ds_read_b64_tr_b16 v[74:75], v18 offset:49664
v_fma_f32 v169, v169, v29, v31
v_fma_f32 v170, v170, v29, v31
v_fma_f32 v171, v171, v29, v31
v_mul_f32 v168, v168, v128
v_mul_f32 v169, v169, v129
v_mul_f32 v170, v170, v130
v_mfma_f32_32x32x16_bf16 v[216:231], v[84:87], a[60:63], v[216:231]
ds_read_b64_tr_b16 v[76:77], v18 offset:51200
ds_read_b64_tr_b16 v[78:79], v18 offset:51712
v_mul_f32 v171, v171, v131
v_exp_f32 v168, v168
v_exp_f32 v169, v169
v_exp_f32 v170, v170
v_exp_f32 v171, v171
s_waitcnt lgkmcnt(5)
v_mfma_f32_32x32x16_bf16 v[216:231], v[56:59], a[64:67], v[216:231]
ds_read_b64_tr_b16 v[80:81], v18 offset:53248
ds_read_b64_tr_b16 v[82:83], v18 offset:53760
v_fma_f32 v168, v168, v30, v30
v_fma_f32 v169, v169, v30, v30
v_fma_f32 v170, v170, v30, v30
v_fma_f32 v171, v171, v30, v30
v_rcp_f32 v168, v168
v_mfma_f32_32x32x16_bf16 v[216:231], v[60:63], a[68:71], v[216:231]
ds_read_b64_tr_b16 v[84:85], v18 offset:55296
ds_read_b64_tr_b16 v[86:87], v18 offset:55808
v_rcp_f32 v169, v169
v_rcp_f32 v170, v170
v_rcp_f32 v171, v171
v_mul_f32 v128, v128, v168
v_mul_f32 v129, v129, v169
v_mfma_f32_32x32x16_bf16 v[216:231], v[64:67], a[72:75], v[216:231]
ds_read_b64_tr_b16 v[56:57], v18 offset:57344
ds_read_b64_tr_b16 v[58:59], v18 offset:57856
v_mul_f32 v130, v130, v170
v_mul_f32 v131, v131, v171
v_cvt_pk_bf16_f32 v180, v128, v129
v_cvt_pk_bf16_f32 v181, v130, v131
v_mul_f32 v168, v132, v132
v_mfma_f32_32x32x16_bf16 v[216:231], v[68:71], a[76:79], v[216:231]
ds_read_b64_tr_b16 v[60:61], v18 offset:59392
ds_read_b64_tr_b16 v[62:63], v18 offset:59904
v_mul_f32 v169, v133, v133
v_mul_f32 v170, v134, v134
v_mul_f32 v171, v135, v135
v_fma_f32 v168, v168, v29, v31
v_fma_f32 v169, v169, v29, v31
s_waitcnt lgkmcnt(4)
v_mfma_f32_32x32x16_bf16 v[216:231], v[72:75], a[80:83], v[216:231]
ds_read_b64_tr_b16 v[64:65], v18 offset:61440
ds_read_b64_tr_b16 v[66:67], v18 offset:61952
v_fma_f32 v170, v170, v29, v31
v_fma_f32 v171, v171, v29, v31
v_mul_f32 v168, v168, v132
v_mul_f32 v169, v169, v133
v_mul_f32 v170, v170, v134
v_mfma_f32_32x32x16_bf16 v[216:231], v[76:79], a[84:87], v[216:231]
ds_read_b64_tr_b16 v[68:69], v18 offset:63488
ds_read_b64_tr_b16 v[70:71], v18 offset:64000
v_mul_f32 v171, v171, v135
v_exp_f32 v168, v168
v_exp_f32 v169, v169
v_exp_f32 v170, v170
v_exp_f32 v171, v171
v_mfma_f32_32x32x16_bf16 v[216:231], v[80:83], a[88:91], v[216:231]
v_fma_f32 v168, v168, v30, v30
v_fma_f32 v169, v169, v30, v30
v_fma_f32 v170, v170, v30, v30
v_fma_f32 v171, v171, v30, v30
v_rcp_f32 v168, v168
v_mfma_f32_32x32x16_bf16 v[216:231], v[84:87], a[92:95], v[216:231]
v_rcp_f32 v169, v169
v_rcp_f32 v170, v170
v_rcp_f32 v171, v171
v_mul_f32 v132, v132, v168
v_mul_f32 v133, v133, v169
s_waitcnt lgkmcnt(0)
v_mfma_f32_32x32x16_bf16 v[216:231], v[56:59], a[96:99], v[216:231]
v_mul_f32 v134, v134, v170
v_mul_f32 v135, v135, v171
v_cvt_pk_bf16_f32 v182, v132, v133
v_cvt_pk_bf16_f32 v183, v134, v135
ds_write_b128 v22, v[180:183] offset:1024
v_mfma_f32_32x32x16_bf16 v[216:231], v[60:63], a[100:103], v[216:231]
s_waitcnt vmcnt(2) lgkmcnt(0)
s_barrier
ds_read_b128 a[112:115], v23 offset:0
ds_read_b128 a[116:119], v23 offset:1024
ds_read_b128 a[120:123], v23 offset:2048
ds_read_b128 a[124:127], v23 offset:3072
ds_read_b64 v[156:157], v27 offset:1024
v_mfma_f32_32x32x16_bf16 v[216:231], v[64:67], a[104:107], v[216:231]
ds_read_b64_tr_b16 v[72:73], v19 offset:0
ds_read_b64_tr_b16 v[74:75], v19 offset:512
ds_read_b64_tr_b16 v[76:77], v19 offset:2048
ds_read_b64_tr_b16 v[78:79], v19 offset:2560
s_add_u32 m0, s54, 8192
s_add_u32 s55, s66, 57344
buffer_load_dwordx4 v6, s[24:27], s55 offen lds
v_mfma_f32_32x32x16_bf16 v[216:231], v[68:71], a[108:111], v[216:231]
ds_read_b64_tr_b16 v[80:81], v19 offset:4096
ds_read_b64_tr_b16 v[82:83], v19 offset:4608
ds_read_b64_tr_b16 v[84:85], v19 offset:6144
ds_read_b64_tr_b16 v[86:87], v19 offset:6656
s_waitcnt lgkmcnt(6)
v_mfma_f32_32x32x16_bf16 v[120:135], v[72:75], a[0:3], 0
ds_read_b64_tr_b16 v[56:57], v19 offset:8192
ds_read_b64_tr_b16 v[58:59], v19 offset:8704
ds_read_b64_tr_b16 v[60:61], v19 offset:10240
ds_read_b64_tr_b16 v[62:63], v19 offset:10752
buffer_load_dwordx4 v7, s[24:27], s55 offen offset:1024 lds
v_mfma_f32_32x32x16_bf16 v[216:231], v[156:159], v[152:155], v[216:231]
s_waitcnt lgkmcnt(8)
v_mfma_f32_32x32x16_bf16 v[120:135], v[76:79], a[4:7], v[120:135]
ds_read_b64_tr_b16 v[64:65], v19 offset:12288
ds_read_b64_tr_b16 v[66:67], v19 offset:12800
ds_read_b64_tr_b16 v[68:69], v19 offset:14336
ds_read_b64_tr_b16 v[70:71], v19 offset:14848
s_add_u32 m0, s54, 16384
s_add_u32 s55, s66, 114688
buffer_load_dwordx4 v6, s[24:27], s55 offen lds
v_mul_f32 v168, v136, v136
v_mul_f32 v169, v137, v137
v_mul_f32 v170, v138, v138
v_mul_f32 v171, v139, v139
v_fma_f32 v168, v168, v29, v31
v_fma_f32 v169, v169, v29, v31
s_waitcnt lgkmcnt(10)
v_mfma_f32_32x32x16_bf16 v[120:135], v[80:83], a[8:11], v[120:135]
ds_read_b64_tr_b16 v[72:73], v19 offset:16384
ds_read_b64_tr_b16 v[74:75], v19 offset:16896
buffer_load_dwordx4 v7, s[24:27], s55 offen offset:1024 lds
v_fma_f32 v170, v170, v29, v31
v_fma_f32 v171, v171, v29, v31
v_mul_f32 v168, v168, v136
v_mul_f32 v169, v169, v137
v_mul_f32 v170, v170, v138
v_mul_f32 v171, v171, v139
s_waitcnt lgkmcnt(10)
v_mfma_f32_32x32x16_bf16 v[120:135], v[84:87], a[12:15], v[120:135]
ds_read_b64_tr_b16 v[76:77], v19 offset:18432
ds_read_b64_tr_b16 v[78:79], v19 offset:18944
s_add_u32 m0, s54, 24576
s_add_u32 s55, s66, 172032
buffer_load_dwordx4 v6, s[24:27], s55 offen lds
v_exp_f32 v168, v168
v_exp_f32 v169, v169
v_exp_f32 v170, v170
v_exp_f32 v171, v171
v_fma_f32 v168, v168, v30, v30
s_waitcnt lgkmcnt(4)
v_mfma_f32_32x32x16_bf16 v[120:135], v[56:59], a[16:19], v[120:135]
ds_read_b64_tr_b16 v[80:81], v19 offset:20480
ds_read_b64_tr_b16 v[82:83], v19 offset:20992
buffer_load_dwordx4 v7, s[24:27], s55 offen offset:1024 lds
v_fma_f32 v169, v169, v30, v30
v_fma_f32 v170, v170, v30, v30
v_fma_f32 v171, v171, v30, v30
v_rcp_f32 v168, v168
v_rcp_f32 v169, v169
v_mfma_f32_32x32x16_bf16 v[120:135], v[60:63], a[20:23], v[120:135]
ds_read_b64_tr_b16 v[84:85], v19 offset:22528
ds_read_b64_tr_b16 v[86:87], v19 offset:23040
s_add_u32 m0, s54, 32768
s_nop 0
buffer_load_dwordx4 v4, s[28:31], s73 offen lds
v_rcp_f32 v170, v170
v_rcp_f32 v171, v171
v_mul_f32 v136, v136, v168
v_mul_f32 v137, v137, v169
v_mul_f32 v138, v138, v170
v_mfma_f32_32x32x16_bf16 v[120:135], v[64:67], a[24:27], v[120:135]
ds_read_b64_tr_b16 v[56:57], v19 offset:24576
ds_read_b64_tr_b16 v[58:59], v19 offset:25088
s_lshl_b32 s98, s5, 1
s_add_u32 s98, s98, s49
s_lshl_b32 s98, s98, 8
v_mov_b32 v47, s98
global_load_dword v46, v47, s[6:7] sc1
v_and_b32 v254, 31, v0
v_lshrrev_b32 v2, 5, v0
v_lshlrev_b32 v254, 3, v254
v_lshl_add_u32 v254, v2, 12, v254
s_sub_u32 s98, 32, s4
s_lshl_b32 s98, s98, 8
v_add_u32 v254, s98, v254
buffer_load_dwordx4 v5, s[28:31], s73 offen offset:1024 lds
v_mul_f32 v139, v139, v171
v_cvt_pk_bf16_f32 v176, v136, v137
v_cvt_pk_bf16_f32 v177, v138, v139
v_mul_f32 v168, v140, v140
v_mul_f32 v169, v141, v141
v_mfma_f32_32x32x16_bf16 v[120:135], v[68:71], a[28:31], v[120:135]
ds_read_b64_tr_b16 v[60:61], v19 offset:26624
ds_read_b64_tr_b16 v[62:63], v19 offset:27136
s_add_u32 m0, s54, 40960
s_nop 0
buffer_load_dwordx4 v4, s[32:35], s73 offen lds
v_mul_f32 v170, v142, v142
v_mul_f32 v171, v143, v143
v_fma_f32 v168, v168, v29, v31
v_fma_f32 v169, v169, v29, v31
v_fma_f32 v170, v170, v29, v31
s_waitcnt lgkmcnt(4)
v_mfma_f32_32x32x16_bf16 v[120:135], v[72:75], a[32:35], v[120:135]
ds_read_b64_tr_b16 v[64:65], v19 offset:28672
ds_read_b64_tr_b16 v[66:67], v19 offset:29184
buffer_load_dwordx4 v5, s[32:35], s73 offen offset:1024 lds
v_fma_f32 v171, v171, v29, v31
v_mul_f32 v168, v168, v140
v_mul_f32 v169, v169, v141
v_mul_f32 v170, v170, v142
v_mul_f32 v171, v171, v143
v_mfma_f32_32x32x16_bf16 v[120:135], v[76:79], a[36:39], v[120:135]
ds_read_b64_tr_b16 v[68:69], v19 offset:30720
ds_read_b64_tr_b16 v[70:71], v19 offset:31232
s_add_u32 m0, s54, 49152
s_add_u32 s55, s67, 0
buffer_load_dwordx4 v6, s[24:27], s55 offen lds
v_exp_f32 v168, v168
v_exp_f32 v169, v169
v_exp_f32 v170, v170
v_exp_f32 v171, v171
v_fma_f32 v168, v168, v30, v30
v_mfma_f32_32x32x16_bf16 v[120:135], v[80:83], a[40:43], v[120:135]
ds_read_b64_tr_b16 v[72:73], v19 offset:32768
ds_read_b64_tr_b16 v[74:75], v19 offset:33280
buffer_load_dwordx4 v7, s[24:27], s55 offen offset:1024 lds
v_fma_f32 v169, v169, v30, v30
v_fma_f32 v170, v170, v30, v30
v_fma_f32 v171, v171, v30, v30
v_rcp_f32 v168, v168
v_rcp_f32 v169, v169
v_mfma_f32_32x32x16_bf16 v[120:135], v[84:87], a[44:47], v[120:135]
ds_read_b64_tr_b16 v[76:77], v19 offset:34816
ds_read_b64_tr_b16 v[78:79], v19 offset:35328
s_add_u32 m0, s54, 57344
s_add_u32 s55, s67, 57344
buffer_load_dwordx4 v6, s[24:27], s55 offen lds
v_rcp_f32 v170, v170
v_rcp_f32 v171, v171
v_mul_f32 v140, v140, v168
v_mul_f32 v141, v141, v169
v_mul_f32 v142, v142, v170
s_waitcnt lgkmcnt(4)
v_mfma_f32_32x32x16_bf16 v[120:135], v[56:59], a[48:51], v[120:135]
ds_read_b64_tr_b16 v[80:81], v19 offset:36864
ds_read_b64_tr_b16 v[82:83], v19 offset:37376
buffer_load_dwordx4 v7, s[24:27], s55 offen offset:1024 lds
v_mul_f32 v143, v143, v171
v_cvt_pk_bf16_f32 v178, v140, v141
v_cvt_pk_bf16_f32 v179, v142, v143
v_mfma_f32_32x32x16_bf16 v[120:135], v[60:63], a[52:55], v[120:135]
ds_read_b64_tr_b16 v[84:85], v19 offset:38912
ds_read_b64_tr_b16 v[86:87], v19 offset:39424
ds_write_b128 v22, v[176:179] offset:8192
v_mul_f32 v168, v144, v144
v_mul_f32 v169, v145, v145
v_mul_f32 v170, v146, v146
v_mul_f32 v171, v147, v147
v_fma_f32 v168, v168, v29, v31
v_mfma_f32_32x32x16_bf16 v[120:135], v[64:67], a[56:59], v[120:135]
ds_read_b64_tr_b16 v[56:57], v19 offset:40960
ds_read_b64_tr_b16 v[58:59], v19 offset:41472
v_fma_f32 v169, v169, v29, v31
v_fma_f32 v170, v170, v29, v31
v_fma_f32 v171, v171, v29, v31
v_mul_f32 v168, v168, v144
v_mul_f32 v169, v169, v145
v_mul_f32 v170, v170, v146
v_mfma_f32_32x32x16_bf16 v[120:135], v[68:71], a[60:63], v[120:135]
ds_read_b64_tr_b16 v[60:61], v19 offset:43008
ds_read_b64_tr_b16 v[62:63], v19 offset:43520
s_waitcnt vmcnt(7)
v_readfirstlane_b32 s98, v46
s_cmp_ge_u32 s98, 32
s_cbranch_scc1 L_sok3
s_mov_b32 s99, 0
L_spin3:
global_load_dword v46, v47, s[6:7] sc1
s_waitcnt vmcnt(0)
v_readfirstlane_b32 s98, v46
s_cmp_ge_u32 s98, 32
s_cbranch_scc1 L_sok3
s_add_u32 s99, s99, 1
s_cmp_gt_u32 s99, 400000
s_cbranch_scc1 L_sok3
s_sleep 3
s_branch L_spin3
L_sok3:
buffer_load_dwordx2 v[214:215], v254, s[36:39], 0 offen offset:3840 sc1
v_mul_f32 v171, v171, v147
v_exp_f32 v168, v168
v_exp_f32 v169, v169
v_exp_f32 v170, v170
v_exp_f32 v171, v171
s_waitcnt lgkmcnt(5)
v_mfma_f32_32x32x16_bf16 v[120:135], v[72:75], a[64:67], v[120:135]
ds_read_b64_tr_b16 v[64:65], v19 offset:45056
ds_read_b64_tr_b16 v[66:67], v19 offset:45568
buffer_load_dwordx2 v[212:213], v254, s[36:39], 0 offen offset:3584 sc1
v_fma_f32 v168, v168, v30, v30
v_fma_f32 v169, v169, v30, v30
v_fma_f32 v170, v170, v30, v30
v_fma_f32 v171, v171, v30, v30
v_rcp_f32 v168, v168
v_mfma_f32_32x32x16_bf16 v[120:135], v[76:79], a[68:71], v[120:135]
ds_read_b64_tr_b16 v[68:69], v19 offset:47104
ds_read_b64_tr_b16 v[70:71], v19 offset:47616
buffer_load_dwordx2 v[210:211], v254, s[36:39], 0 offen offset:3328 sc1
v_rcp_f32 v169, v169
v_rcp_f32 v170, v170
v_rcp_f32 v171, v171
v_mul_f32 v144, v144, v168
v_mul_f32 v145, v145, v169
v_mfma_f32_32x32x16_bf16 v[120:135], v[80:83], a[72:75], v[120:135]
ds_read_b64_tr_b16 v[72:73], v19 offset:49152
ds_read_b64_tr_b16 v[74:75], v19 offset:49664
buffer_load_dwordx2 v[208:209], v254, s[36:39], 0 offen offset:3072 sc1
v_mul_f32 v146, v146, v170
v_mul_f32 v147, v147, v171
v_cvt_pk_bf16_f32 v180, v144, v145
v_cvt_pk_bf16_f32 v181, v146, v147
v_mul_f32 v168, v148, v148
v_mfma_f32_32x32x16_bf16 v[120:135], v[84:87], a[76:79], v[120:135]
ds_read_b64_tr_b16 v[76:77], v19 offset:51200
ds_read_b64_tr_b16 v[78:79], v19 offset:51712
buffer_load_dwordx2 v[206:207], v254, s[36:39], 0 offen offset:2816 sc1
v_mul_f32 v169, v149, v149
v_mul_f32 v170, v150, v150
v_mul_f32 v171, v151, v151
v_fma_f32 v168, v168, v29, v31
v_fma_f32 v169, v169, v29, v31
s_waitcnt lgkmcnt(4)
v_mfma_f32_32x32x16_bf16 v[120:135], v[56:59], a[80:83], v[120:135]
ds_read_b64_tr_b16 v[80:81], v19 offset:53248
ds_read_b64_tr_b16 v[82:83], v19 offset:53760
buffer_load_dwordx2 v[204:205], v254, s[36:39], 0 offen offset:2560 sc1
v_fma_f32 v170, v170, v29, v31
v_fma_f32 v171, v171, v29, v31
v_mul_f32 v168, v168, v148
v_mul_f32 v169, v169, v149
v_mul_f32 v170, v170, v150
v_mfma_f32_32x32x16_bf16 v[120:135], v[60:63], a[84:87], v[120:135]
ds_read_b64_tr_b16 v[84:85], v19 offset:55296
ds_read_b64_tr_b16 v[86:87], v19 offset:55808
buffer_load_dwordx2 v[202:203], v254, s[36:39], 0 offen offset:2304 sc1
v_mul_f32 v171, v171, v151
v_exp_f32 v168, v168
v_exp_f32 v169, v169
v_exp_f32 v170, v170
v_exp_f32 v171, v171
v_mfma_f32_32x32x16_bf16 v[120:135], v[64:67], a[88:91], v[120:135]
buffer_load_dwordx2 v[200:201], v254, s[36:39], 0 offen offset:2048 sc1
v_fma_f32 v168, v168, v30, v30
v_fma_f32 v169, v169, v30, v30
v_fma_f32 v170, v170, v30, v30
v_fma_f32 v171, v171, v30, v30
v_rcp_f32 v168, v168
v_mfma_f32_32x32x16_bf16 v[120:135], v[68:71], a[92:95], v[120:135]
buffer_load_dwordx2 v[198:199], v254, s[36:39], 0 offen offset:1792 sc1
v_rcp_f32 v169, v169
v_rcp_f32 v170, v170
v_rcp_f32 v171, v171
v_mul_f32 v148, v148, v168
v_mul_f32 v149, v149, v169
s_waitcnt lgkmcnt(0)
v_mfma_f32_32x32x16_bf16 v[120:135], v[72:75], a[96:99], v[120:135]
buffer_load_dwordx2 v[196:197], v254, s[36:39], 0 offen offset:1536 sc1
v_mul_f32 v150, v150, v170
v_mul_f32 v151, v151, v171
v_cvt_pk_bf16_f32 v182, v148, v149
v_cvt_pk_bf16_f32 v183, v150, v151
ds_write_b128 v22, v[180:183] offset:9216
v_mfma_f32_32x32x16_bf16 v[120:135], v[76:79], a[100:103], v[120:135]
buffer_load_dwordx2 v[194:195], v254, s[36:39], 0 offen offset:1280 sc1
s_waitcnt lgkmcnt(0)
s_barrier
ds_read_b128 a[128:131], v23 offset:8192
ds_read_b128 a[132:135], v23 offset:9216
ds_read_b128 a[136:139], v23 offset:10240
ds_read_b128 a[140:143], v23 offset:11264
ds_read_b64 v[160:161], v27 offset:1536
v_mfma_f32_32x32x16_bf16 v[120:135], v[80:83], a[104:107], v[120:135]
ds_read_b64_tr_b16 v[56:57], v20 offset:0
ds_read_b64_tr_b16 v[58:59], v20 offset:1024
ds_read_b64_tr_b16 v[60:61], v20 offset:2048
ds_read_b64_tr_b16 v[62:63], v20 offset:3072
buffer_load_dwordx2 v[192:193], v254, s[36:39], 0 offen offset:1024 sc1
v_mfma_f32_32x32x16_bf16 v[120:135], v[84:87], a[108:111], v[120:135]
ds_read_b64_tr_b16 v[64:65], v20 offset:4096
ds_read_b64_tr_b16 v[66:67], v20 offset:5120
ds_read_b64_tr_b16 v[68:69], v20 offset:6144
ds_read_b64_tr_b16 v[70:71], v20 offset:7168
buffer_load_dwordx2 v[190:191], v254, s[36:39], 0 offen offset:768 sc1
s_waitcnt lgkmcnt(6)
v_mfma_f32_32x32x16_bf16 v[136:151], a[112:115], v[56:59], 0
ds_read_b64_tr_b16 v[72:73], v20 offset:8192
ds_read_b64_tr_b16 v[74:75], v20 offset:9216
ds_read_b64_tr_b16 v[76:77], v20 offset:10240
ds_read_b64_tr_b16 v[78:79], v20 offset:11264
buffer_load_dwordx2 v[188:189], v254, s[36:39], 0 offen offset:512 sc1
v_mul_f32 v168, v216, v216
v_mfma_f32_32x32x16_bf16 v[120:135], v[160:163], v[152:155], v[120:135]
v_mul_f32 v169, v217, v217
v_mul_f32 v170, v218, v218
v_mul_f32 v171, v219, v219
v_fma_f32 v168, v168, v29, v31
v_fma_f32 v169, v169, v29, v31
v_fma_f32 v170, v170, v29, v31
v_fma_f32 v171, v171, v29, v31
v_mul_f32 v168, v168, v216
v_mul_f32 v169, v169, v217
v_mul_f32 v170, v170, v218
v_mul_f32 v171, v171, v219
v_exp_f32 v168, v168
v_exp_f32 v169, v169
v_exp_f32 v170, v170
v_exp_f32 v171, v171
v_fma_f32 v168, v168, v30, v30
v_fma_f32 v169, v169, v30, v30
v_fma_f32 v170, v170, v30, v30
v_fma_f32 v171, v171, v30, v30
v_rcp_f32 v168, v168
v_rcp_f32 v169, v169
v_rcp_f32 v170, v170
v_rcp_f32 v171, v171
v_mul_f32 v216, v216, v168
v_mul_f32 v217, v217, v169
v_mul_f32 v218, v218, v170
v_mul_f32 v219, v219, v171
v_cvt_pk_bf16_f32 v176, v216, v217
v_cvt_pk_bf16_f32 v177, v218, v219
v_mul_f32 v168, v220, v220
v_mul_f32 v169, v221, v221
v_mul_f32 v170, v222, v222
v_mul_f32 v171, v223, v223
v_fma_f32 v168, v168, v29, v31
v_fma_f32 v169, v169, v29, v31
v_fma_f32 v170, v170, v29, v31
v_fma_f32 v171, v171, v29, v31
v_mul_f32 v168, v168, v220
v_mul_f32 v169, v169, v221
v_mul_f32 v170, v170, v222
v_mul_f32 v171, v171, v223
v_exp_f32 v168, v168
v_exp_f32 v169, v169
v_exp_f32 v170, v170
v_exp_f32 v171, v171
v_fma_f32 v168, v168, v30, v30
v_fma_f32 v169, v169, v30, v30
v_fma_f32 v170, v170, v30, v30
v_fma_f32 v171, v171, v30, v30
v_rcp_f32 v168, v168
v_rcp_f32 v169, v169
v_rcp_f32 v170, v170
v_rcp_f32 v171, v171
v_mul_f32 v220, v220, v168
v_mul_f32 v221, v221, v169
v_mul_f32 v222, v222, v170
v_mul_f32 v223, v223, v171
v_cvt_pk_bf16_f32 v178, v220, v221
v_cvt_pk_bf16_f32 v179, v222, v223
s_waitcnt lgkmcnt(8)
v_mfma_f32_32x32x16_bf16 v[136:151], a[116:119], v[60:63], v[136:151]
ds_read_b64_tr_b16 v[80:81], v20 offset:12288
ds_read_b64_tr_b16 v[82:83], v20 offset:13312
ds_read_b64_tr_b16 v[84:85], v20 offset:14336
ds_read_b64_tr_b16 v[86:87], v20 offset:15360
buffer_load_dwordx2 v[186:187], v254, s[36:39], 0 offen offset:256 sc1
ds_write_b128 v22, v[176:179] offset:0
v_mul_f32 v168, v224, v224
v_mul_f32 v169, v225, v225
v_mul_f32 v170, v226, v226
v_mul_f32 v171, v227, v227
v_fma_f32 v168, v168, v29, v31
v_fma_f32 v169, v169, v29, v31
v_fma_f32 v170, v170, v29, v31
v_fma_f32 v171, v171, v29, v31
v_mul_f32 v168, v168, v224
v_mul_f32 v169, v169, v225
v_mul_f32 v170, v170, v226
v_mul_f32 v171, v171, v227
v_exp_f32 v168, v168
v_exp_f32 v169, v169
v_exp_f32 v170, v170
v_exp_f32 v171, v171
v_fma_f32 v168, v168, v30, v30
v_fma_f32 v169, v169, v30, v30
v_fma_f32 v170, v170, v30, v30
v_fma_f32 v171, v171, v30, v30
v_rcp_f32 v168, v168
v_rcp_f32 v169, v169
v_rcp_f32 v170, v170
v_rcp_f32 v171, v171
v_mul_f32 v224, v224, v168
v_mul_f32 v225, v225, v169
v_mul_f32 v226, v226, v170
v_mul_f32 v227, v227, v171
v_cvt_pk_bf16_f32 v180, v224, v225
v_cvt_pk_bf16_f32 v181, v226, v227
v_mul_f32 v168, v228, v228
v_mul_f32 v169, v229, v229
v_mul_f32 v170, v230, v230
v_mul_f32 v171, v231, v231
v_fma_f32 v168, v168, v29, v31
v_fma_f32 v169, v169, v29, v31
v_fma_f32 v170, v170, v29, v31
v_fma_f32 v171, v171, v29, v31
v_mul_f32 v168, v168, v228
v_mul_f32 v169, v169, v229
v_mul_f32 v170, v170, v230
v_mul_f32 v171, v171, v231
v_exp_f32 v168, v168
v_exp_f32 v169, v169
v_exp_f32 v170, v170
v_exp_f32 v171, v171
v_fma_f32 v168, v168, v30, v30
v_fma_f32 v169, v169, v30, v30
v_fma_f32 v170, v170, v30, v30
v_fma_f32 v171, v171, v30, v30
v_rcp_f32 v168, v168
v_rcp_f32 v169, v169
v_rcp_f32 v170, v170
v_rcp_f32 v171, v171
v_mul_f32 v228, v228, v168
v_mul_f32 v229, v229, v169
v_mul_f32 v230, v230, v170
v_mul_f32 v231, v231, v171
v_cvt_pk_bf16_f32 v182, v228, v229
v_cvt_pk_bf16_f32 v183, v230, v231
ds_write_b128 v22, v[180:183] offset:1024
s_waitcnt lgkmcnt(12)
v_mfma_f32_32x32x16_bf16 v[136:151], a[120:123], v[64:67], v[136:151]
ds_read_b64_tr_b16 v[56:57], v20 offset:16384
ds_read_b64_tr_b16 v[58:59], v20 offset:17408
buffer_load_dwordx2 v[184:185], v254, s[36:39], 0 offen offset:0 sc1
v_mul_f32 v168, v120, v120
v_mul_f32 v169, v121, v121
v_mul_f32 v170, v122, v122
v_mul_f32 v171, v123, v123
v_fma_f32 v168, v168, v29, v31
v_fma_f32 v169, v169, v29, v31
v_fma_f32 v170, v170, v29, v31
v_fma_f32 v171, v171, v29, v31
v_mul_f32 v168, v168, v120
v_mul_f32 v169, v169, v121
v_mul_f32 v170, v170, v122
v_mul_f32 v171, v171, v123
v_exp_f32 v168, v168
v_exp_f32 v169, v169
v_exp_f32 v170, v170
v_exp_f32 v171, v171
v_fma_f32 v168, v168, v30, v30
v_fma_f32 v169, v169, v30, v30
v_fma_f32 v170, v170, v30, v30
v_fma_f32 v171, v171, v30, v30
v_rcp_f32 v168, v168
v_rcp_f32 v169, v169
v_rcp_f32 v170, v170
v_rcp_f32 v171, v171
v_mul_f32 v120, v120, v168
v_mul_f32 v121, v121, v169
v_mul_f32 v122, v122, v170
v_mul_f32 v123, v123, v171
v_cvt_pk_bf16_f32 v176, v120, v121
v_cvt_pk_bf16_f32 v177, v122, v123
v_mul_f32 v168, v124, v124
v_mul_f32 v169, v125, v125
v_mul_f32 v170, v126, v126
v_mul_f32 v171, v127, v127
v_fma_f32 v168, v168, v29, v31
v_fma_f32 v169, v169, v29, v31
v_fma_f32 v170, v170, v29, v31
v_fma_f32 v171, v171, v29, v31
v_mul_f32 v168, v168, v124
v_mul_f32 v169, v169, v125
v_mul_f32 v170, v170, v126
v_mul_f32 v171, v171, v127
v_exp_f32 v168, v168
v_exp_f32 v169, v169
v_exp_f32 v170, v170
v_exp_f32 v171, v171
v_fma_f32 v168, v168, v30, v30
v_fma_f32 v169, v169, v30, v30
v_fma_f32 v170, v170, v30, v30
v_fma_f32 v171, v171, v30, v30
v_rcp_f32 v168, v168
v_rcp_f32 v169, v169
v_rcp_f32 v170, v170
v_rcp_f32 v171, v171
v_mul_f32 v124, v124, v168
v_mul_f32 v125, v125, v169
v_mul_f32 v126, v126, v170
v_mul_f32 v127, v127, v171
v_cvt_pk_bf16_f32 v178, v124, v125
v_cvt_pk_bf16_f32 v179, v126, v127
s_waitcnt lgkmcnt(12)
v_mfma_f32_32x32x16_bf16 v[136:151], a[124:127], v[68:71], v[136:151]
ds_read_b64_tr_b16 v[60:61], v20 offset:18432
ds_read_b64_tr_b16 v[62:63], v20 offset:19456
s_add_u32 m0, s54, 65536
s_add_u32 s55, s67, 114688
buffer_load_dwordx4 v6, s[24:27], s55 offen lds
ds_write_b128 v22, v[176:179] offset:8192
v_mul_f32 v168, v128, v128
v_mul_f32 v169, v129, v129
v_mul_f32 v170, v130, v130
v_mul_f32 v171, v131, v131
v_fma_f32 v168, v168, v29, v31
v_fma_f32 v169, v169, v29, v31
v_fma_f32 v170, v170, v29, v31
v_fma_f32 v171, v171, v29, v31
v_mul_f32 v168, v168, v128
v_mul_f32 v169, v169, v129
v_mul_f32 v170, v170, v130
v_mul_f32 v171, v171, v131
v_exp_f32 v168, v168
v_exp_f32 v169, v169
v_exp_f32 v170, v170
v_exp_f32 v171, v171
v_fma_f32 v168, v168, v30, v30
v_fma_f32 v169, v169, v30, v30
v_fma_f32 v170, v170, v30, v30
v_fma_f32 v171, v171, v30, v30
v_rcp_f32 v168, v168
v_rcp_f32 v169, v169
v_rcp_f32 v170, v170
v_rcp_f32 v171, v171
v_mul_f32 v128, v128, v168
v_mul_f32 v129, v129, v169
v_mul_f32 v130, v130, v170
v_mul_f32 v131, v131, v171
v_cvt_pk_bf16_f32 v180, v128, v129
v_cvt_pk_bf16_f32 v181, v130, v131
v_mul_f32 v168, v132, v132
v_mul_f32 v169, v133, v133
v_mul_f32 v170, v134, v134
v_mul_f32 v171, v135, v135
v_fma_f32 v168, v168, v29, v31
v_fma_f32 v169, v169, v29, v31
v_fma_f32 v170, v170, v29, v31
v_fma_f32 v171, v171, v29, v31
v_mul_f32 v168, v168, v132
v_mul_f32 v169, v169, v133
v_mul_f32 v170, v170, v134
v_mul_f32 v171, v171, v135
v_exp_f32 v168, v168
v_exp_f32 v169, v169
v_exp_f32 v170, v170
v_exp_f32 v171, v171
v_fma_f32 v168, v168, v30, v30
v_fma_f32 v169, v169, v30, v30
v_fma_f32 v170, v170, v30, v30
v_fma_f32 v171, v171, v30, v30
v_rcp_f32 v168, v168
v_rcp_f32 v169, v169
v_rcp_f32 v170, v170
v_rcp_f32 v171, v171
v_mul_f32 v132, v132, v168
v_mul_f32 v133, v133, v169
v_mul_f32 v134, v134, v170
v_mul_f32 v135, v135, v171
v_cvt_pk_bf16_f32 v182, v132, v133
v_cvt_pk_bf16_f32 v183, v134, v135
ds_write_b128 v22, v[180:183] offset:9216
s_waitcnt lgkmcnt(8)
v_mfma_f32_32x32x16_bf16 v[136:151], a[128:131], v[72:75], v[136:151]
ds_read_b64_tr_b16 v[64:65], v20 offset:20480
ds_read_b64_tr_b16 v[66:67], v20 offset:21504
buffer_load_dwordx4 v7, s[24:27], s55 offen offset:1024 lds
s_waitcnt lgkmcnt(2)
s_barrier
ds_read_b128 a[144:147], v23 offset:0
ds_read_b128 a[148:151], v23 offset:1024
ds_read_b128 a[152:155], v23 offset:2048
ds_read_b128 a[156:159], v23 offset:3072
ds_read_b128 a[160:163], v23 offset:8192
ds_read_b128 a[164:167], v23 offset:9216
ds_read_b128 a[168:171], v23 offset:10240
ds_read_b128 a[172:175], v23 offset:11264
v_mfma_f32_32x32x16_bf16 v[136:151], a[132:135], v[76:79], v[136:151]
ds_read_b64_tr_b16 v[68:69], v20 offset:22528
ds_read_b64_tr_b16 v[70:71], v20 offset:23552
s_add_u32 m0, s54, 73728
s_add_u32 s55, s67, 172032
buffer_load_dwordx4 v6, s[24:27], s55 offen lds
s_waitcnt vmcnt(17)
v_fma_f32 v50, v214, v36, v212
v_fma_f32 v51, v214, v37, v213
v_fma_f32 v50, -v215, v37, v50
v_fmac_f32 v51, v215, v36
s_waitcnt vmcnt(16)
v_fma_f32 v52, v50, v36, v210
v_fma_f32 v53, v50, v37, v211
v_fma_f32 v52, -v51, v37, v52
v_fmac_f32 v53, v51, v36
s_waitcnt vmcnt(15)
v_fma_f32 v50, v52, v36, v208
v_fma_f32 v51, v52, v37, v209
v_fma_f32 v50, -v53, v37, v50
v_fmac_f32 v51, v53, v36
s_waitcnt vmcnt(14)
v_fma_f32 v52, v50, v36, v206
v_fma_f32 v53, v50, v37, v207
v_fma_f32 v52, -v51, v37, v52
v_fmac_f32 v53, v51, v36
s_waitcnt vmcnt(13)
v_fma_f32 v50, v52, v36, v204
v_fma_f32 v51, v52, v37, v205
v_fma_f32 v50, -v53, v37, v50
v_fmac_f32 v51, v53, v36
s_waitcnt vmcnt(12)
v_fma_f32 v52, v50, v36, v202
v_fma_f32 v53, v50, v37, v203
v_fma_f32 v52, -v51, v37, v52
v_fmac_f32 v53, v51, v36
s_waitcnt vmcnt(11)
v_fma_f32 v50, v52, v36, v200
v_fma_f32 v51, v52, v37, v201
v_fma_f32 v50, -v53, v37, v50
v_fmac_f32 v51, v53, v36
s_waitcnt vmcnt(10)
v_fma_f32 v52, v50, v36, v198
v_fma_f32 v53, v50, v37, v199
v_fma_f32 v52, -v51, v37, v52
v_fmac_f32 v53, v51, v36
s_waitcnt vmcnt(9)
v_fma_f32 v50, v52, v36, v196
v_fma_f32 v51, v52, v37, v197
v_fma_f32 v50, -v53, v37, v50
v_fmac_f32 v51, v53, v36
v_mfma_f32_32x32x16_bf16 v[136:151], a[136:139], v[80:83], v[136:151]
buffer_load_dwordx4 v7, s[24:27], s55 offen offset:1024 lds
s_waitcnt vmcnt(9)
v_fma_f32 v52, v50, v36, v194
v_fma_f32 v53, v50, v37, v195
v_fma_f32 v52, -v51, v37, v52
v_fmac_f32 v53, v51, v36
s_waitcnt vmcnt(8)
v_fma_f32 v50, v52, v36, v192
v_fma_f32 v51, v52, v37, v193
v_fma_f32 v50, -v53, v37, v50
v_fmac_f32 v51, v53, v36
s_waitcnt vmcnt(7)
v_fma_f32 v52, v50, v36, v190
v_fma_f32 v53, v50, v37, v191
v_fma_f32 v52, -v51, v37, v52
v_fmac_f32 v53, v51, v36
s_waitcnt vmcnt(6)
v_fma_f32 v50, v52, v36, v188
v_fma_f32 v51, v52, v37, v189
v_fma_f32 v50, -v53, v37, v50
v_fmac_f32 v51, v53, v36
s_waitcnt vmcnt(5)
v_fma_f32 v52, v50, v36, v186
v_fma_f32 v53, v50, v37, v187
v_fma_f32 v52, -v51, v37, v52
v_fmac_f32 v53, v51, v36
s_waitcnt vmcnt(4)
v_fma_f32 v50, v52, v36, v184
v_fma_f32 v51, v52, v37, v185
v_fma_f32 v50, -v53, v37, v50
v_fmac_f32 v51, v53, v36
v_mov_b32 v52, v50
v_mov_b32 v53, v51
s_nop 0
v_permlane32_swap_b32 v50, v52
v_permlane32_swap_b32 v51, v53
v_fma_f32 v50, v38, v52, v50
v_fma_f32 v51, v38, v53, v51
v_fma_f32 v50, -v39, v53, v50
v_fmac_f32 v51, v39, v52
v_fma_f32 v52, v50, v40, v44
v_fma_f32 v53, v50, v41, v45
v_fma_f32 v52, -v51, v41, v52
v_fmac_f32 v53, v51, v40
v_mfma_f32_32x32x16_bf16 v[136:151], a[140:143], v[84:87], v[136:151]
s_add_u32 m0, s54, 81920
s_nop 0
buffer_load_dwordx4 v4, s[28:31], s74 offen lds
v_fma_f32 v88, v52, v32, v88
v_fma_f32 v104, v52, v33, v104
v_fma_f32 v88, -v53, v33, v88
v_fmac_f32 v104, v53, v32
v_fma_f32 v89, v88, v32, v89
v_fma_f32 v105, v88, v33, v105
v_fma_f32 v89, -v104, v33, v89
v_fmac_f32 v105, v104, v32
v_cvt_pk_bf16_f32 v232, v88, v89
v_cvt_pk_bf16_f32 v240, -v104, -v105
v_fma_f32 v90, v89, v32, v90
v_fma_f32 v106, v89, v33, v106
v_fma_f32 v90, -v105, v33, v90
v_fmac_f32 v106, v105, v32
v_fma_f32 v91, v90, v32, v91
v_fma_f32 v107, v90, v33, v107
v_fma_f32 v91, -v106, v33, v91
v_fmac_f32 v107, v106, v32
v_cvt_pk_bf16_f32 v233, v90, v91
v_cvt_pk_bf16_f32 v241, -v106, -v107
v_fma_f32 v92, v91, v32, v92
v_fma_f32 v108, v91, v33, v108
v_fma_f32 v92, -v107, v33, v92
v_fmac_f32 v108, v107, v32
v_fma_f32 v93, v92, v32, v93
v_fma_f32 v109, v92, v33, v109
v_fma_f32 v93, -v108, v33, v93
v_fmac_f32 v109, v108, v32
s_waitcnt lgkmcnt(0)
v_mfma_f32_32x32x16_bf16 v[136:151], a[144:147], v[56:59], v[136:151]
buffer_load_dwordx4 v5, s[28:31], s74 offen offset:1024 lds
v_cvt_pk_bf16_f32 v234, v92, v93
v_cvt_pk_bf16_f32 v242, -v108, -v109
v_fma_f32 v94, v93, v32, v94
v_fma_f32 v110, v93, v33, v110
v_fma_f32 v94, -v109, v33, v94
v_fmac_f32 v110, v109, v32
v_fma_f32 v95, v94, v32, v95
v_fma_f32 v111, v94, v33, v111
v_fma_f32 v95, -v110, v33, v95
v_fmac_f32 v111, v110, v32
v_cvt_pk_bf16_f32 v235, v94, v95
v_cvt_pk_bf16_f32 v243, -v110, -v111
v_fma_f32 v96, v95, v32, v96
v_fma_f32 v112, v95, v33, v112
v_fma_f32 v96, -v111, v33, v96
v_fmac_f32 v112, v111, v32
v_fma_f32 v97, v96, v32, v97
v_fma_f32 v113, v96, v33, v113
v_fma_f32 v97, -v112, v33, v97
v_fmac_f32 v113, v112, v32
v_cvt_pk_bf16_f32 v236, v96, v97
v_cvt_pk_bf16_f32 v244, -v112, -v113
v_fma_f32 v98, v97, v32, v98
v_fma_f32 v114, v97, v33, v114
v_fma_f32 v98, -v113, v33, v98
v_fmac_f32 v114, v113, v32
v_fma_f32 v99, v98, v32, v99
v_fma_f32 v115, v98, v33, v115
v_mfma_f32_32x32x16_bf16 v[136:151], a[148:151], v[60:63], v[136:151]
s_add_u32 m0, s54, 90112
s_nop 0
buffer_load_dwordx4 v4, s[32:35], s74 offen lds
v_fma_f32 v99, -v114, v33, v99
v_fmac_f32 v115, v114, v32
v_cvt_pk_bf16_f32 v237, v98, v99
v_cvt_pk_bf16_f32 v245, -v114, -v115
v_fma_f32 v100, v99, v32, v100
v_fma_f32 v116, v99, v33, v116
v_fma_f32 v100, -v115, v33, v100
v_fmac_f32 v116, v115, v32
v_fma_f32 v101, v100, v32, v101
v_fma_f32 v117, v100, v33, v117
v_fma_f32 v101, -v116, v33, v101
v_fmac_f32 v117, v116, v32
v_cvt_pk_bf16_f32 v238, v100, v101
v_cvt_pk_bf16_f32 v246, -v116, -v117
v_fma_f32 v102, v101, v32, v102
v_fma_f32 v118, v101, v33, v118
v_fma_f32 v102, -v117, v33, v102
v_fmac_f32 v118, v117, v32
v_fma_f32 v103, v102, v32, v103
v_fma_f32 v119, v102, v33, v119
v_fma_f32 v103, -v118, v33, v103
v_fmac_f32 v119, v118, v32
v_cvt_pk_bf16_f32 v239, v102, v103
v_cvt_pk_bf16_f32 v247, -v118, -v119
ds_write_b128 v24, v[232:235]
ds_write_b128 v24, v[236:239] offset:16
ds_write_b128 v24, v[240:243] offset:4096
ds_write_b128 v24, v[244:247] offset:4112
s_waitcnt lgkmcnt(0)
s_barrier
ds_read_b64_tr_b16 a[176:177], v25 offset:0
ds_read_b64_tr_b16 a[178:179], v25 offset:256
ds_read_b64_tr_b16 a[180:181], v25 offset:1024
ds_read_b64_tr_b16 a[182:183], v25 offset:1280
ds_read_b64_tr_b16 a[184:185], v25 offset:2048
ds_read_b64_tr_b16 a[186:187], v25 offset:2304
ds_read_b64_tr_b16 a[188:189], v25 offset:3072
ds_read_b64_tr_b16 a[190:191], v25 offset:3328
ds_read_b64_tr_b16 a[192:193], v25 offset:4096
ds_read_b64_tr_b16 a[194:195], v25 offset:4352
ds_read_b64_tr_b16 a[196:197], v25 offset:5120
ds_read_b64_tr_b16 a[198:199], v25 offset:5376
ds_read_b64_tr_b16 a[200:201], v25 offset:6144
ds_read_b64_tr_b16 a[202:203], v25 offset:6400
ds_read_b64_tr_b16 a[204:205], v25 offset:7168
ds_read_b64_tr_b16 a[206:207], v25 offset:7424
v_mfma_f32_32x32x16_bf16 v[136:151], a[152:155], v[64:67], v[136:151]
ds_read_b64_tr_b16 v[72:73], v20 offset:24576
ds_read_b64_tr_b16 v[74:75], v20 offset:25600
ds_read_b64_tr_b16 v[76:77], v20 offset:26624
ds_read_b64_tr_b16 v[78:79], v20 offset:27648
buffer_load_dwordx4 v5, s[32:35], s74 offen offset:1024 lds
v_mfma_f32_32x32x16_bf16 v[136:151], a[156:159], v[68:71], v[136:151]
ds_read_b64_tr_b16 v[80:81], v20 offset:28672
ds_read_b64_tr_b16 v[82:83], v20 offset:29696
ds_read_b64_tr_b16 v[84:85], v20 offset:30720
ds_read_b64_tr_b16 v[86:87], v20 offset:31744
s_add_u32 m0, s54, 98304
s_add_u32 s55, s68, 0
buffer_load_dwordx4 v6, s[24:27], s55 offen lds
s_waitcnt lgkmcnt(6)
v_mfma_f32_32x32x16_bf16 v[136:151], a[160:163], v[72:75], v[136:151]
ds_read_b128 v[56:59], v10 offset:32768
ds_read_b128 v[60:63], v11 offset:32768
buffer_load_dwordx4 v7, s[24:27], s55 offen offset:1024 lds
s_waitcnt lgkmcnt(6)
v_mfma_f32_32x32x16_bf16 v[136:151], a[164:167], v[76:79], v[136:151]
ds_read_b128 v[64:67], v12 offset:32768
ds_read_b128 v[68:71], v13 offset:32768
s_add_u32 m0, s54, 106496
s_add_u32 s55, s68, 57344
buffer_load_dwordx4 v6, s[24:27], s55 offen lds
s_waitcnt lgkmcnt(6)
v_mfma_f32_32x32x16_bf16 v[136:151], a[168:171], v[80:83], v[136:151]
ds_read_b128 v[72:75], v10 offset:40960
buffer_load_dwordx4 v7, s[24:27], s55 offen offset:1024 lds
s_waitcnt lgkmcnt(5)
v_mfma_f32_32x32x16_bf16 v[136:151], a[172:175], v[84:87], v[136:151]
ds_read_b128 v[76:79], v11 offset:40960
s_add_u32 m0, s54, 114688
s_add_u32 s55, s68, 114688
buffer_load_dwordx4 v6, s[24:27], s55 offen lds
s_waitcnt lgkmcnt(2)
v_mfma_f32_32x32x16_bf16 v[136:151], a[176:179], v[56:59], v[136:151]
ds_read_b128 v[80:83], v12 offset:40960
buffer_load_dwordx4 v7, s[24:27], s55 offen offset:1024 lds
v_mfma_f32_32x32x16_bf16 v[136:151], a[180:183], v[60:63], v[136:151]
ds_read_b128 v[84:87], v13 offset:40960
s_add_u32 m0, s54, 0
s_add_u32 s55, s68, 172032
buffer_load_dwordx4 v6, s[24:27], s55 offen lds
v_mfma_f32_32x32x16_bf16 v[136:151], a[184:187], v[64:67], v[136:151]
buffer_load_dwordx4 v7, s[24:27], s55 offen offset:1024 lds
v_mfma_f32_32x32x16_bf16 v[136:151], a[188:191], v[68:71], v[136:151]
s_add_u32 m0, s54, 8192
s_nop 0
buffer_load_dwordx4 v4, s[28:31], s75 offen lds
s_waitcnt lgkmcnt(0)
v_mfma_f32_32x32x16_bf16 v[136:151], a[192:195], v[72:75], v[136:151]
buffer_load_dwordx4 v5, s[28:31], s75 offen offset:1024 lds
v_mfma_f32_32x32x16_bf16 v[136:151], a[196:199], v[76:79], v[136:151]
s_add_u32 m0, s54, 16384
s_nop 0
buffer_load_dwordx4 v4, s[32:35], s75 offen lds
s_waitcnt vmcnt(17)
s_barrier
v_mfma_f32_32x32x16_bf16 v[136:151], a[200:203], v[80:83], v[136:151]
ds_read_b64_tr_b16 v[56:57], v20 offset:49152
ds_read_b64_tr_b16 v[58:59], v20 offset:50176
ds_read_b64_tr_b16 v[60:61], v20 offset:51200
ds_read_b64_tr_b16 v[62:63], v20 offset:52224
buffer_load_dwordx4 v5, s[32:35], s75 offen offset:1024 lds
v_mfma_f32_32x32x16_bf16 v[136:151], a[204:207], v[84:87], v[136:151]
ds_read_b64_tr_b16 v[64:65], v20 offset:53248
ds_read_b64_tr_b16 v[66:67], v20 offset:54272
ds_read_b64_tr_b16 v[68:69], v20 offset:55296
ds_read_b64_tr_b16 v[70:71], v20 offset:56320
s_add_u32 m0, s54, 24576
s_add_u32 s55, s69, 0
buffer_load_dwordx4 v6, s[24:27], s55 offen lds
s_waitcnt lgkmcnt(6)
v_mfma_f32_32x32x16_bf16 v[216:231], a[112:115], v[56:59], 0
ds_read_b64_tr_b16 v[72:73], v20 offset:57344
ds_read_b64_tr_b16 v[74:75], v20 offset:58368
ds_read_b64_tr_b16 v[76:77], v20 offset:59392
ds_read_b64_tr_b16 v[78:79], v20 offset:60416
buffer_load_dwordx4 v7, s[24:27], s55 offen offset:1024 lds
s_waitcnt lgkmcnt(8)
v_mfma_f32_32x32x16_bf16 v[216:231], a[116:119], v[60:63], v[216:231]
ds_read_b64_tr_b16 v[80:81], v20 offset:61440
ds_read_b64_tr_b16 v[82:83], v20 offset:62464
ds_read_b64_tr_b16 v[84:85], v20 offset:63488
ds_read_b64_tr_b16 v[86:87], v20 offset:64512
s_add_u32 m0, s54, 32768
s_add_u32 s55, s69, 57344
buffer_load_dwordx4 v6, s[24:27], s55 offen lds
v_cvt_pk_bf16_f32 v232, v136, v137
v_cvt_pk_bf16_f32 v233, v138, v139
v_cvt_pk_bf16_f32 v234, v140, v141
s_waitcnt lgkmcnt(10)
v_mfma_f32_32x32x16_bf16 v[216:231], a[120:123], v[64:67], v[216:231]
ds_read_b64_tr_b16 v[56:57], v21 offset:0
ds_read_b64_tr_b16 v[58:59], v21 offset:1024
buffer_load_dwordx4 v7, s[24:27], s55 offen offset:1024 lds
v_cvt_pk_bf16_f32 v235, v142, v143
v_cvt_pk_bf16_f32 v236, v144, v145
v_cvt_pk_bf16_f32 v237, v146, v147
s_waitcnt lgkmcnt(10)
v_mfma_f32_32x32x16_bf16 v[216:231], a[124:127], v[68:71], v[216:231]
ds_read_b64_tr_b16 v[60:61], v21 offset:2048
ds_read_b64_tr_b16 v[62:63], v21 offset:3072
s_add_u32 m0, s54, 40960
s_add_u32 s55, s69, 114688
buffer_load_dwordx4 v6, s[24:27], s55 offen lds
v_cvt_pk_bf16_f32 v238, v148, v149
v_cvt_pk_bf16_f32 v239, v150, v151
s_waitcnt lgkmcnt(4)
v_mfma_f32_32x32x16_bf16 v[216:231], a[128:131], v[72:75], v[216:231]
ds_read_b64_tr_b16 v[64:65], v21 offset:4096
ds_read_b64_tr_b16 v[66:67], v21 offset:5120
buffer_load_dwordx4 v7, s[24:27], s55 offen offset:1024 lds
v_mfma_f32_32x32x16_bf16 v[216:231], a[132:135], v[76:79], v[216:231]
ds_read_b64_tr_b16 v[68:69], v21 offset:6144
ds_read_b64_tr_b16 v[70:71], v21 offset:7168
buffer_store_dwordx4 v[232:235], v248, s[40:43], s82 offen sc1
v_mfma_f32_32x32x16_bf16 v[216:231], a[136:139], v[80:83], v[216:231]
v_mfma_f32_32x32x16_bf16 v[216:231], a[140:143], v[84:87], v[216:231]
buffer_store_dwordx4 v[236:239], v248, s[40:43], s82 offen offset:1024 sc1
s_waitcnt lgkmcnt(0)
v_mfma_f32_32x32x16_bf16 v[216:231], a[144:147], v[56:59], v[216:231]
v_mfma_f32_32x32x16_bf16 v[216:231], a[148:151], v[60:63], v[216:231]
s_waitcnt vmcnt(20)
s_barrier
v_mfma_f32_32x32x16_bf16 v[216:231], a[152:155], v[64:67], v[216:231]
ds_read_b64_tr_b16 v[72:73], v21 offset:8192
ds_read_b64_tr_b16 v[74:75], v21 offset:9216
ds_read_b64_tr_b16 v[76:77], v21 offset:10240
ds_read_b64_tr_b16 v[78:79], v21 offset:11264
s_add_u32 m0, s54, 49152
s_add_u32 s55, s69, 172032
buffer_load_dwordx4 v6, s[24:27], s55 offen lds
v_mfma_f32_32x32x16_bf16 v[216:231], a[156:159], v[68:71], v[216:231]
ds_read_b64_tr_b16 v[80:81], v21 offset:12288
ds_read_b64_tr_b16 v[82:83], v21 offset:13312
ds_read_b64_tr_b16 v[84:85], v21 offset:14336
ds_read_b64_tr_b16 v[86:87], v21 offset:15360
buffer_load_dwordx4 v7, s[24:27], s55 offen offset:1024 lds
s_waitcnt lgkmcnt(6)
v_mfma_f32_32x32x16_bf16 v[216:231], a[160:163], v[72:75], v[216:231]
ds_read_b128 v[56:59], v14 offset:16384
ds_read_b128 v[60:63], v15 offset:16384
s_add_u32 m0, s54, 57344
s_nop 0
buffer_load_dwordx4 v4, s[28:31], s76 offen lds
s_waitcnt lgkmcnt(6)
v_mfma_f32_32x32x16_bf16 v[216:231], a[164:167], v[76:79], v[216:231]
ds_read_b128 v[64:67], v16 offset:16384
ds_read_b128 v[68:71], v17 offset:16384
buffer_load_dwordx4 v5, s[28:31], s76 offen offset:1024 lds
s_waitcnt lgkmcnt(6)
v_mfma_f32_32x32x16_bf16 v[216:231], a[168:171], v[80:83], v[216:231]
ds_read_b128 v[72:75], v14 offset:24576
s_add_u32 m0, s54, 65536
s_nop 0
buffer_load_dwordx4 v4, s[32:35], s76 offen lds
s_waitcnt lgkmcnt(5)
v_mfma_f32_32x32x16_bf16 v[216:231], a[172:175], v[84:87], v[216:231]
ds_read_b128 v[76:79], v15 offset:24576
buffer_load_dwordx4 v5, s[32:35], s76 offen offset:1024 lds
s_waitcnt lgkmcnt(2)
v_mfma_f32_32x32x16_bf16 v[216:231], a[176:179], v[56:59], v[216:231]
ds_read_b128 v[80:83], v16 offset:24576
v_mfma_f32_32x32x16_bf16 v[216:231], a[180:183], v[60:63], v[216:231]
ds_read_b128 v[84:87], v17 offset:24576
v_mfma_f32_32x32x16_bf16 v[216:231], a[184:187], v[64:67], v[216:231]
v_mfma_f32_32x32x16_bf16 v[216:231], a[188:191], v[68:71], v[216:231]
s_waitcnt lgkmcnt(0)
v_mfma_f32_32x32x16_bf16 v[216:231], a[192:195], v[72:75], v[216:231]
v_mfma_f32_32x32x16_bf16 v[216:231], a[196:199], v[76:79], v[216:231]
s_waitcnt vmcnt(20)
s_barrier
v_mfma_f32_32x32x16_bf16 v[216:231], a[200:203], v[80:83], v[216:231]
ds_read_b64_tr_b16 v[56:57], v21 offset:32768
ds_read_b64_tr_b16 v[58:59], v21 offset:33792
ds_read_b64_tr_b16 v[60:61], v21 offset:34816
ds_read_b64_tr_b16 v[62:63], v21 offset:35840
s_add_u32 m0, s54, 73728
s_add_u32 s55, s70, 0
buffer_load_dwordx4 v6, s[24:27], s55 offen lds
v_mfma_f32_32x32x16_bf16 v[216:231], a[204:207], v[84:87], v[216:231]
ds_read_b64_tr_b16 v[64:65], v21 offset:36864
ds_read_b64_tr_b16 v[66:67], v21 offset:37888
ds_read_b64_tr_b16 v[68:69], v21 offset:38912
ds_read_b64_tr_b16 v[70:71], v21 offset:39936
buffer_load_dwordx4 v7, s[24:27], s55 offen offset:1024 lds
s_waitcnt lgkmcnt(6)
v_mfma_f32_32x32x16_bf16 v[136:151], a[112:115], v[56:59], 0
ds_read_b64_tr_b16 v[72:73], v21 offset:40960
ds_read_b64_tr_b16 v[74:75], v21 offset:41984
ds_read_b64_tr_b16 v[76:77], v21 offset:43008
ds_read_b64_tr_b16 v[78:79], v21 offset:44032
s_add_u32 m0, s54, 81920
s_add_u32 s55, s70, 57344
buffer_load_dwordx4 v6, s[24:27], s55 offen lds
s_waitcnt lgkmcnt(8)
v_mfma_f32_32x32x16_bf16 v[136:151], a[116:119], v[60:63], v[136:151]
ds_read_b64_tr_b16 v[80:81], v21 offset:45056
ds_read_b64_tr_b16 v[82:83], v21 offset:46080
ds_read_b64_tr_b16 v[84:85], v21 offset:47104
ds_read_b64_tr_b16 v[86:87], v21 offset:48128
buffer_load_dwordx4 v7, s[24:27], s55 offen offset:1024 lds
v_cvt_pk_bf16_f32 v232, v216, v217
v_cvt_pk_bf16_f32 v233, v218, v219
v_cvt_pk_bf16_f32 v234, v220, v221
s_waitcnt lgkmcnt(10)
v_mfma_f32_32x32x16_bf16 v[136:151], a[120:123], v[64:67], v[136:151]
ds_read_b64_tr_b16 v[56:57], v21 offset:49152
ds_read_b64_tr_b16 v[58:59], v21 offset:50176
s_add_u32 m0, s54, 90112
s_add_u32 s55, s70, 114688
buffer_load_dwordx4 v6, s[24:27], s55 offen lds
v_cvt_pk_bf16_f32 v235, v222, v223
v_cvt_pk_bf16_f32 v236, v224, v225
v_cvt_pk_bf16_f32 v237, v226, v227
s_waitcnt lgkmcnt(10)
v_mfma_f32_32x32x16_bf16 v[136:151], a[124:127], v[68:71], v[136:151]
ds_read_b64_tr_b16 v[60:61], v21 offset:51200
ds_read_b64_tr_b16 v[62:63], v21 offset:52224
buffer_load_dwordx4 v7, s[24:27], s55 offen offset:1024 lds
v_cvt_pk_bf16_f32 v238, v228, v229
v_cvt_pk_bf16_f32 v239, v230, v231
s_waitcnt lgkmcnt(4)
v_mfma_f32_32x32x16_bf16 v[136:151], a[128:131], v[72:75], v[136:151]
ds_read_b64_tr_b16 v[64:65], v21 offset:53248
ds_read_b64_tr_b16 v[66:67], v21 offset:54272
buffer_store_dwordx4 v[232:235], v248, s[40:43], s83 offen sc1
v_mfma_f32_32x32x16_bf16 v[136:151], a[132:135], v[76:79], v[136:151]
ds_read_b64_tr_b16 v[68:69], v21 offset:55296
ds_read_b64_tr_b16 v[70:71], v21 offset:56320
v_mfma_f32_32x32x16_bf16 v[136:151], a[136:139], v[80:83], v[136:151]
buffer_store_dwordx4 v[236:239], v248, s[40:43], s83 offen offset:1024 sc1
ds_read_b128 v[168:171], v26 offset:256
ds_read_b128 v[172:175], v26 offset:272
ds_read_b128 v[176:179], v26 offset:288
v_mfma_f32_32x32x16_bf16 v[136:151], a[140:143], v[84:87], v[136:151]
ds_read_b128 v[180:183], v26 offset:304
ds_read_b128 v[184:187], v26 offset:0
ds_read_b128 v[188:191], v26 offset:16
s_waitcnt lgkmcnt(6)
v_mfma_f32_32x32x16_bf16 v[136:151], a[144:147], v[56:59], v[136:151]
ds_read_b128 v[192:195], v26 offset:32
ds_read_b128 v[196:199], v26 offset:48
v_accvgpr_read_b32 v153, a212
v_mfma_f32_32x32x16_bf16 v[136:151], a[148:151], v[60:63], v[136:151]
v_lshlrev_b32 v152, 16, v153
v_and_b32 v153, s59, v153
s_waitcnt lgkmcnt(7)
v_sub_f32 v88, v152, v168
s_waitcnt vmcnt(22)
s_barrier
v_mfma_f32_32x32x16_bf16 v[136:151], a[152:155], v[64:67], v[136:151]
ds_read_b64_tr_b16 v[72:73], v20 offset:0
ds_read_b64_tr_b16 v[74:75], v20 offset:1024
ds_read_b64_tr_b16 v[76:77], v20 offset:2048
ds_read_b64_tr_b16 v[78:79], v20 offset:3072
s_add_u32 m0, s54, 98304
s_add_u32 s55, s70, 172032
buffer_load_dwordx4 v6, s[24:27], s55 offen lds
v_sub_f32 v89, v153, v169
v_add_f32 v152, v152, v251
v_cvt_pk_bf16_f32 v90, v88, v89
v_mfma_f32_32x32x16_bf16 v[136:151], a[156:159], v[68:71], v[136:151]
ds_read_b64_tr_b16 v[80:81], v20 offset:4096
ds_read_b64_tr_b16 v[82:83], v20 offset:5120
ds_read_b64_tr_b16 v[84:85], v20 offset:6144
ds_read_b64_tr_b16 v[86:87], v20 offset:7168
buffer_load_dwordx4 v7, s[24:27], s55 offen offset:1024 lds
v_add_f32 v153, v153, v251
v_lshlrev_b32 v88, 16, v90
v_and_b32 v89, s59, v90
s_waitcnt lgkmcnt(6)
v_mfma_f32_32x32x16_bf16 v[136:151], a[160:163], v[72:75], v[136:151]
ds_read_b128 v[56:59], v10 offset:8192
ds_read_b128 v[60:63], v11 offset:8192
s_add_u32 m0, s54, 106496
s_nop 0
buffer_load_dwordx4 v4, s[28:31], s77 offen lds
v_mul_f32 v88, v88, v184
v_mul_f32 v89, v89, v185
v_cvt_pk_bf16_f32 v90, v88, v89
s_waitcnt lgkmcnt(6)
v_mfma_f32_32x32x16_bf16 v[136:151], a[164:167], v[76:79], v[136:151]
ds_read_b128 v[64:67], v12 offset:8192
ds_read_b128 v[68:71], v13 offset:8192
buffer_load_dwordx4 v5, s[28:31], s77 offen offset:1024 lds
v_lshlrev_b32 v88, 16, v90
v_and_b32 v89, s59, v90
v_mul_f32 v88, v88, v250
s_waitcnt lgkmcnt(6)
v_mfma_f32_32x32x16_bf16 v[136:151], a[168:171], v[80:83], v[136:151]
ds_read_b128 v[72:75], v10 offset:16384
v_mov_b32 v48, 0
global_load_dword v49, v48, s[94:95] sc1
s_add_u32 m0, s54, 114688
s_nop 0
buffer_load_dwordx4 v4, s[32:35], s77 offen lds
v_mul_f32 v89, v89, v250
v_cvt_pk_bf16_f32 v90, v88, v89
v_lshlrev_b32 v88, 16, v90
s_waitcnt lgkmcnt(5)
v_mfma_f32_32x32x16_bf16 v[136:151], a[172:175], v[84:87], v[136:151]
ds_read_b128 v[76:79], v11 offset:16384
buffer_load_dwordx4 v5, s[32:35], s77 offen offset:1024 lds
v_and_b32 v89, s59, v90
v_add_f32 v152, v152, v88
v_add_f32 v153, v153, v89
s_waitcnt lgkmcnt(2)
v_mfma_f32_32x32x16_bf16 v[136:151], a[176:179], v[56:59], v[136:151]
ds_read_b128 v[80:83], v12 offset:16384
v_accvgpr_read_b32 v155, a213
v_lshlrev_b32 v154, 16, v155
v_and_b32 v155, s59, v155
v_mfma_f32_32x32x16_bf16 v[136:151], a[180:183], v[60:63], v[136:151]
ds_read_b128 v[84:87], v13 offset:16384
v_sub_f32 v88, v154, v170
v_sub_f32 v89, v155, v171
v_add_f32 v154, v154, v251
v_mfma_f32_32x32x16_bf16 v[136:151], a[184:187], v[64:67], v[136:151]
v_cvt_pk_bf16_f32 v90, v88, v89
v_add_f32 v155, v155, v251
v_mfma_f32_32x32x16_bf16 v[136:151], a[188:191], v[68:71], v[136:151]
v_lshlrev_b32 v88, 16, v90
v_and_b32 v89, s59, v90
s_waitcnt lgkmcnt(0)
v_mfma_f32_32x32x16_bf16 v[136:151], a[192:195], v[72:75], v[136:151]
v_mul_f32 v88, v88, v186
v_mul_f32 v89, v89, v187
v_mfma_f32_32x32x16_bf16 v[136:151], a[196:199], v[76:79], v[136:151]
v_cvt_pk_bf16_f32 v90, v88, v89
v_lshlrev_b32 v88, 16, v90
s_waitcnt vmcnt(23)
s_barrier
v_mfma_f32_32x32x16_bf16 v[136:151], a[200:203], v[80:83], v[136:151]
ds_read_b64_tr_b16 v[56:57], v20 offset:24576
ds_read_b64_tr_b16 v[58:59], v20 offset:25600
ds_read_b64_tr_b16 v[60:61], v20 offset:26624
ds_read_b64_tr_b16 v[62:63], v20 offset:27648
s_add_u32 m0, s54, 0
s_add_u32 s55, s71, 0
buffer_load_dwordx4 v6, s[24:27], s55 offen lds
v_and_b32 v89, s59, v90
v_mul_f32 v88, v88, v250
v_mfma_f32_32x32x16_bf16 v[136:151], a[204:207], v[84:87], v[136:151]
ds_read_b64_tr_b16 v[64:65], v20 offset:28672
ds_read_b64_tr_b16 v[66:67], v20 offset:29696
ds_read_b64_tr_b16 v[68:69], v20 offset:30720
ds_read_b64_tr_b16 v[70:71], v20 offset:31744
buffer_load_dwordx4 v7, s[24:27], s55 offen offset:1024 lds
v_mul_f32 v89, v89, v250
v_cvt_pk_bf16_f32 v90, v88, v89
s_waitcnt lgkmcnt(6)
v_mfma_f32_32x32x16_bf16 v[216:231], a[112:115], v[56:59], 0
ds_read_b64_tr_b16 v[72:73], v20 offset:32768
ds_read_b64_tr_b16 v[74:75], v20 offset:33792
ds_read_b64_tr_b16 v[76:77], v20 offset:34816
ds_read_b64_tr_b16 v[78:79], v20 offset:35840
s_add_u32 m0, s54, 8192
s_add_u32 s55, s71, 57344
buffer_load_dwordx4 v6, s[24:27], s55 offen lds
v_lshlrev_b32 v88, 16, v90
v_and_b32 v89, s59, v90
s_waitcnt lgkmcnt(8)
v_mfma_f32_32x32x16_bf16 v[216:231], a[116:119], v[60:63], v[216:231]
ds_read_b64_tr_b16 v[80:81], v20 offset:36864
ds_read_b64_tr_b16 v[82:83], v20 offset:37888
ds_read_b64_tr_b16 v[84:85], v20 offset:38912
ds_read_b64_tr_b16 v[86:87], v20 offset:39936
buffer_load_dwordx4 v7, s[24:27], s55 offen offset:1024 lds
v_add_f32 v154, v154, v88
v_add_f32 v155, v155, v89
v_cvt_pk_bf16_f32 v232, v136, v137
v_cvt_pk_bf16_f32 v233, v138, v139
v_cvt_pk_bf16_f32 v234, v140, v141
s_waitcnt lgkmcnt(10)
v_mfma_f32_32x32x16_bf16 v[216:231], a[120:123], v[64:67], v[216:231]
ds_read_b64_tr_b16 v[56:57], v20 offset:40960
ds_read_b64_tr_b16 v[58:59], v20 offset:41984
s_add_u32 m0, s54, 16384
s_add_u32 s55, s71, 114688
buffer_load_dwordx4 v6, s[24:27], s55 offen lds
v_accvgpr_read_b32 v157, a214
v_lshlrev_b32 v156, 16, v157
v_cvt_pk_bf16_f32 v235, v142, v143
v_cvt_pk_bf16_f32 v236, v144, v145
v_cvt_pk_bf16_f32 v237, v146, v147
s_waitcnt lgkmcnt(10)
v_mfma_f32_32x32x16_bf16 v[216:231], a[124:127], v[68:71], v[216:231]
ds_read_b64_tr_b16 v[60:61], v20 offset:43008
ds_read_b64_tr_b16 v[62:63], v20 offset:44032
buffer_load_dwordx4 v7, s[24:27], s55 offen offset:1024 lds
v_and_b32 v157, s59, v157
v_sub_f32 v88, v156, v172
v_cvt_pk_bf16_f32 v238, v148, v149
v_cvt_pk_bf16_f32 v239, v150, v151
s_waitcnt lgkmcnt(4)
v_mfma_f32_32x32x16_bf16 v[216:231], a[128:131], v[72:75], v[216:231]
ds_read_b64_tr_b16 v[64:65], v20 offset:45056
ds_read_b64_tr_b16 v[66:67], v20 offset:46080
buffer_store_dwordx4 v[232:235], v248, s[40:43], s84 offen sc1
v_sub_f32 v89, v157, v173
v_add_f32 v156, v156, v251
v_mfma_f32_32x32x16_bf16 v[216:231], a[132:135], v[76:79], v[216:231]
ds_read_b64_tr_b16 v[68:69], v20 offset:47104
ds_read_b64_tr_b16 v[70:71], v20 offset:48128
v_cvt_pk_bf16_f32 v90, v88, v89
v_add_f32 v157, v157, v251
v_mfma_f32_32x32x16_bf16 v[216:231], a[136:139], v[80:83], v[216:231]
buffer_store_dwordx4 v[236:239], v248, s[40:43], s84 offen offset:1024 sc1
v_lshlrev_b32 v88, 16, v90
v_and_b32 v89, s59, v90
v_mfma_f32_32x32x16_bf16 v[216:231], a[140:143], v[84:87], v[216:231]
v_mul_f32 v88, v88, v188
v_mul_f32 v89, v89, v189
s_waitcnt lgkmcnt(0)
v_mfma_f32_32x32x16_bf16 v[216:231], a[144:147], v[56:59], v[216:231]
v_cvt_pk_bf16_f32 v90, v88, v89
v_lshlrev_b32 v88, 16, v90
v_mfma_f32_32x32x16_bf16 v[216:231], a[148:151], v[60:63], v[216:231]
v_and_b32 v89, s59, v90
v_mul_f32 v88, v88, v250
s_waitcnt vmcnt(23)
s_barrier
v_mfma_f32_32x32x16_bf16 v[216:231], a[152:155], v[64:67], v[216:231]
ds_read_b64_tr_b16 v[72:73], v20 offset:49152
ds_read_b64_tr_b16 v[74:75], v20 offset:50176
ds_read_b64_tr_b16 v[76:77], v20 offset:51200
ds_read_b64_tr_b16 v[78:79], v20 offset:52224
s_add_u32 m0, s54, 24576
s_add_u32 s55, s71, 172032
buffer_load_dwordx4 v6, s[24:27], s55 offen lds
v_mul_f32 v89, v89, v250
v_cvt_pk_bf16_f32 v90, v88, v89
v_mfma_f32_32x32x16_bf16 v[216:231], a[156:159], v[68:71], v[216:231]
ds_read_b64_tr_b16 v[80:81], v20 offset:53248
ds_read_b64_tr_b16 v[82:83], v20 offset:54272
ds_read_b64_tr_b16 v[84:85], v20 offset:55296
ds_read_b64_tr_b16 v[86:87], v20 offset:56320
buffer_load_dwordx4 v7, s[24:27], s55 offen offset:1024 lds
v_lshlrev_b32 v88, 16, v90
v_and_b32 v89, s59, v90
s_waitcnt lgkmcnt(6)
v_mfma_f32_32x32x16_bf16 v[216:231], a[160:163], v[72:75], v[216:231]
ds_read_b128 v[56:59], v10 offset:57344
ds_read_b128 v[60:63], v11 offset:57344
s_add_u32 m0, s54, 32768
s_nop 0
buffer_load_dwordx4 v4, s[28:31], s78 offen lds
v_add_f32 v156, v156, v88
v_add_f32 v157, v157, v89
s_waitcnt lgkmcnt(6)
v_mfma_f32_32x32x16_bf16 v[216:231], a[164:167], v[76:79], v[216:231]
ds_read_b128 v[64:67], v12 offset:57344
ds_read_b128 v[68:71], v13 offset:57344
buffer_load_dwordx4 v5, s[28:31], s78 offen offset:1024 lds
v_accvgpr_read_b32 v159, a215
v_lshlrev_b32 v158, 16, v159
s_waitcnt lgkmcnt(6)
v_mfma_f32_32x32x16_bf16 v[216:231], a[168:171], v[80:83], v[216:231]
ds_read_b128 v[72:75], v14 offset:0
s_waitcnt vmcnt(14)
v_readfirstlane_b32 s98, v49
s_cmp_ge_u32 s98, 32
s_cbranch_scc1 L_sok5
s_mov_b32 s99, 0
L_spin5:
global_load_dword v49, v48, s[94:95] sc1
s_waitcnt vmcnt(0)
v_readfirstlane_b32 s98, v49
s_cmp_ge_u32 s98, 32
s_cbranch_scc1 L_sok5
s_add_u32 s99, s99, 1
s_cmp_gt_u32 s99, 400000
s_cbranch_scc1 L_sok5
s_sleep 12
s_branch L_spin5
L_sok5:
s_add_u32 m0, s54, 40960
s_nop 0
buffer_load_dwordx4 v4, s[32:35], s78 offen lds
v_and_b32 v159, s59, v159
v_sub_f32 v88, v158, v174
s_waitcnt lgkmcnt(5)
v_mfma_f32_32x32x16_bf16 v[216:231], a[172:175], v[84:87], v[216:231]
ds_read_b128 v[76:79], v15 offset:0
buffer_load_dwordx4 v5, s[32:35], s78 offen offset:1024 lds
v_sub_f32 v89, v159, v175
v_add_f32 v158, v158, v251
s_waitcnt lgkmcnt(2)
v_mfma_f32_32x32x16_bf16 v[216:231], a[176:179], v[56:59], v[216:231]
ds_read_b128 v[80:83], v16 offset:0
v_cvt_pk_bf16_f32 v90, v88, v89
v_add_f32 v159, v159, v251
v_mfma_f32_32x32x16_bf16 v[216:231], a[180:183], v[60:63], v[216:231]
ds_read_b128 v[84:87], v17 offset:0
v_lshlrev_b32 v88, 16, v90
v_and_b32 v89, s59, v90
v_mfma_f32_32x32x16_bf16 v[216:231], a[184:187], v[64:67], v[216:231]
v_mul_f32 v88, v88, v190
v_mul_f32 v89, v89, v191
v_mfma_f32_32x32x16_bf16 v[216:231], a[188:191], v[68:71], v[216:231]
v_cvt_pk_bf16_f32 v90, v88, v89
v_lshlrev_b32 v88, 16, v90
s_waitcnt lgkmcnt(0)
v_mfma_f32_32x32x16_bf16 v[216:231], a[192:195], v[72:75], v[216:231]
v_and_b32 v89, s59, v90
v_mul_f32 v88, v88, v250
v_mfma_f32_32x32x16_bf16 v[216:231], a[196:199], v[76:79], v[216:231]
v_mul_f32 v89, v89, v250
v_cvt_pk_bf16_f32 v90, v88, v89
s_barrier
v_mfma_f32_32x32x16_bf16 v[216:231], a[200:203], v[80:83], v[216:231]
ds_read_b64_tr_b16 v[56:57], v21 offset:8192
ds_read_b64_tr_b16 v[58:59], v21 offset:9216
ds_read_b64_tr_b16 v[60:61], v21 offset:10240
ds_read_b64_tr_b16 v[62:63], v21 offset:11264
s_add_u32 m0, s54, 49152
s_add_u32 s55, s72, 0
buffer_load_dwordx4 v6, s[24:27], s55 offen lds
v_lshlrev_b32 v88, 16, v90
v_and_b32 v89, s59, v90
v_mfma_f32_32x32x16_bf16 v[216:231], a[204:207], v[84:87], v[216:231]
ds_read_b64_tr_b16 v[64:65], v21 offset:12288
ds_read_b64_tr_b16 v[66:67], v21 offset:13312
ds_read_b64_tr_b16 v[68:69], v21 offset:14336
ds_read_b64_tr_b16 v[70:71], v21 offset:15360
buffer_load_dwordx4 v7, s[24:27], s55 offen offset:1024 lds
v_add_f32 v158, v158, v88
v_add_f32 v159, v159, v89
s_waitcnt lgkmcnt(6)
v_mfma_f32_32x32x16_bf16 v[136:151], a[112:115], v[56:59], 0
ds_read_b64_tr_b16 v[72:73], v21 offset:16384
ds_read_b64_tr_b16 v[74:75], v21 offset:17408
ds_read_b64_tr_b16 v[76:77], v21 offset:18432
ds_read_b64_tr_b16 v[78:79], v21 offset:19456
s_add_u32 m0, s54, 57344
s_add_u32 s55, s72, 57344
buffer_load_dwordx4 v6, s[24:27], s55 offen lds
v_accvgpr_read_b32 v161, a216
v_lshlrev_b32 v160, 16, v161
s_waitcnt lgkmcnt(8)
v_mfma_f32_32x32x16_bf16 v[136:151], a[116:119], v[60:63], v[136:151]
ds_read_b64_tr_b16 v[80:81], v21 offset:20480
ds_read_b64_tr_b16 v[82:83], v21 offset:21504
ds_read_b64_tr_b16 v[84:85], v21 offset:22528
ds_read_b64_tr_b16 v[86:87], v21 offset:23552
buffer_load_dwordx4 v7, s[24:27], s55 offen offset:1024 lds
v_and_b32 v161, s59, v161
v_sub_f32 v88, v160, v176
v_cvt_pk_bf16_f32 v232, v216, v217
v_cvt_pk_bf16_f32 v233, v218, v219
v_cvt_pk_bf16_f32 v234, v220, v221
s_waitcnt lgkmcnt(10)
v_mfma_f32_32x32x16_bf16 v[136:151], a[120:123], v[64:67], v[136:151]
ds_read_b64_tr_b16 v[56:57], v21 offset:24576
ds_read_b64_tr_b16 v[58:59], v21 offset:25600
s_add_u32 m0, s54, 65536
s_add_u32 s55, s72, 114688
buffer_load_dwordx4 v6, s[24:27], s55 offen lds
v_sub_f32 v89, v161, v177
v_add_f32 v160, v160, v251
v_cvt_pk_bf16_f32 v235, v222, v223
v_cvt_pk_bf16_f32 v236, v224, v225
v_cvt_pk_bf16_f32 v237, v226, v227
s_waitcnt lgkmcnt(10)
v_mfma_f32_32x32x16_bf16 v[136:151], a[124:127], v[68:71], v[136:151]
ds_read_b64_tr_b16 v[60:61], v21 offset:26624
ds_read_b64_tr_b16 v[62:63], v21 offset:27648
buffer_load_dwordx4 v7, s[24:27], s55 offen offset:1024 lds
v_cvt_pk_bf16_f32 v90, v88, v89
v_add_f32 v161, v161, v251
v_cvt_pk_bf16_f32 v238, v228, v229
v_cvt_pk_bf16_f32 v239, v230, v231
s_waitcnt lgkmcnt(4)
v_mfma_f32_32x32x16_bf16 v[136:151], a[128:131], v[72:75], v[136:151]
ds_read_b64_tr_b16 v[64:65], v21 offset:28672
ds_read_b64_tr_b16 v[66:67], v21 offset:29696
buffer_store_dwordx4 v[232:235], v248, s[40:43], s85 offen sc1
v_lshlrev_b32 v88, 16, v90
v_and_b32 v89, s59, v90
v_mfma_f32_32x32x16_bf16 v[136:151], a[132:135], v[76:79], v[136:151]
ds_read_b64_tr_b16 v[68:69], v21 offset:30720
ds_read_b64_tr_b16 v[70:71], v21 offset:31744
v_mul_f32 v88, v88, v192
v_mul_f32 v89, v89, v193
v_mfma_f32_32x32x16_bf16 v[136:151], a[136:139], v[80:83], v[136:151]
buffer_store_dwordx4 v[236:239], v248, s[40:43], s85 offen offset:1024 sc1
v_cvt_pk_bf16_f32 v90, v88, v89
v_lshlrev_b32 v88, 16, v90
v_mfma_f32_32x32x16_bf16 v[136:151], a[140:143], v[84:87], v[136:151]
v_and_b32 v89, s59, v90
v_mul_f32 v88, v88, v250
s_waitcnt lgkmcnt(0)
v_mfma_f32_32x32x16_bf16 v[136:151], a[144:147], v[56:59], v[136:151]
v_mul_f32 v89, v89, v250
v_cvt_pk_bf16_f32 v90, v88, v89
v_mfma_f32_32x32x16_bf16 v[136:151], a[148:151], v[60:63], v[136:151]
v_lshlrev_b32 v88, 16, v90
v_and_b32 v89, s59, v90
s_waitcnt vmcnt(14)
s_barrier
s_lshl_b32 s98, s4, 8
s_add_u32 s98, s98, 4096
v_mov_b32 v47, s98
s_cmp_lg_u32 s3, 0
s_cbranch_scc1 L_ow4
s_mov_b64 exec, 1
v_mov_b32 v1, 1
global_atomic_add v47, v1, s[6:7] sc1
s_mov_b64 exec, -1
L_ow4:
v_mfma_f32_32x32x16_bf16 v[136:151], a[152:155], v[64:67], v[136:151]
ds_read_b64_tr_b16 v[72:73], v21 offset:32768
ds_read_b64_tr_b16 v[74:75], v21 offset:33792
ds_read_b64_tr_b16 v[76:77], v21 offset:34816
ds_read_b64_tr_b16 v[78:79], v21 offset:35840
s_add_u32 m0, s54, 73728
s_add_u32 s55, s72, 172032
buffer_load_dwordx4 v6, s[24:27], s55 offen lds
v_add_f32 v160, v160, v88
v_add_f32 v161, v161, v89
v_mfma_f32_32x32x16_bf16 v[136:151], a[156:159], v[68:71], v[136:151]
ds_read_b64_tr_b16 v[80:81], v21 offset:36864
ds_read_b64_tr_b16 v[82:83], v21 offset:37888
ds_read_b64_tr_b16 v[84:85], v21 offset:38912
ds_read_b64_tr_b16 v[86:87], v21 offset:39936
buffer_load_dwordx4 v7, s[24:27], s55 offen offset:1024 lds
v_accvgpr_read_b32 v163, a217
v_lshlrev_b32 v162, 16, v163
s_waitcnt lgkmcnt(6)
v_mfma_f32_32x32x16_bf16 v[136:151], a[160:163], v[72:75], v[136:151]
ds_read_b128 v[56:59], v14 offset:40960
ds_read_b128 v[60:63], v15 offset:40960
s_add_u32 m0, s54, 81920
s_nop 0
buffer_load_dwordx4 v4, s[28:31], s79 offen lds
v_and_b32 v163, s59, v163
v_sub_f32 v88, v162, v178
s_waitcnt lgkmcnt(6)
v_mfma_f32_32x32x16_bf16 v[136:151], a[164:167], v[76:79], v[136:151]
ds_read_b128 v[64:67], v16 offset:40960
ds_read_b128 v[68:71], v17 offset:40960
buffer_load_dwordx4 v5, s[28:31], s79 offen offset:1024 lds
v_sub_f32 v89, v163, v179
v_add_f32 v162, v162, v251
s_waitcnt lgkmcnt(6)
v_mfma_f32_32x32x16_bf16 v[136:151], a[168:171], v[80:83], v[136:151]
ds_read_b128 v[72:75], v14 offset:49152
s_add_u32 m0, s54, 90112
s_nop 0
buffer_load_dwordx4 v4, s[32:35], s79 offen lds
v_cvt_pk_bf16_f32 v90, v88, v89
v_add_f32 v163, v163, v251
s_waitcnt lgkmcnt(5)
v_mfma_f32_32x32x16_bf16 v[136:151], a[172:175], v[84:87], v[136:151]
ds_read_b128 v[76:79], v15 offset:49152
buffer_load_dwordx4 v5, s[32:35], s79 offen offset:1024 lds
v_lshlrev_b32 v88, 16, v90
v_and_b32 v89, s59, v90
s_waitcnt lgkmcnt(2)
v_mfma_f32_32x32x16_bf16 v[136:151], a[176:179], v[56:59], v[136:151]
ds_read_b128 v[80:83], v16 offset:49152
v_mul_f32 v88, v88, v194
v_mul_f32 v89, v89, v195
v_mfma_f32_32x32x16_bf16 v[136:151], a[180:183], v[60:63], v[136:151]
ds_read_b128 v[84:87], v17 offset:49152
v_cvt_pk_bf16_f32 v90, v88, v89
v_lshlrev_b32 v88, 16, v90
v_mfma_f32_32x32x16_bf16 v[136:151], a[184:187], v[64:67], v[136:151]
v_and_b32 v89, s59, v90
v_mul_f32 v88, v88, v250
v_mfma_f32_32x32x16_bf16 v[136:151], a[188:191], v[68:71], v[136:151]
v_mul_f32 v89, v89, v250
v_cvt_pk_bf16_f32 v90, v88, v89
s_waitcnt lgkmcnt(0)
v_mfma_f32_32x32x16_bf16 v[136:151], a[192:195], v[72:75], v[136:151]
v_lshlrev_b32 v88, 16, v90
v_and_b32 v89, s59, v90
v_mfma_f32_32x32x16_bf16 v[136:151], a[196:199], v[76:79], v[136:151]
v_add_f32 v162, v162, v88
v_add_f32 v163, v163, v89
s_barrier
v_mfma_f32_32x32x16_bf16 v[136:151], a[200:203], v[80:83], v[136:151]
ds_read_b64_tr_b16 v[56:57], v20 offset:0
ds_read_b64_tr_b16 v[58:59], v20 offset:1024
ds_read_b64_tr_b16 v[60:61], v20 offset:2048
ds_read_b64_tr_b16 v[62:63], v20 offset:3072
v_accvgpr_read_b32 v165, a218
v_lshlrev_b32 v164, 16, v165
v_mfma_f32_32x32x16_bf16 v[136:151], a[204:207], v[84:87], v[136:151]
ds_read_b64_tr_b16 v[64:65], v20 offset:4096
ds_read_b64_tr_b16 v[66:67], v20 offset:5120
ds_read_b64_tr_b16 v[68:69], v20 offset:6144
ds_read_b64_tr_b16 v[70:71], v20 offset:7168
v_and_b32 v165, s59, v165
v_sub_f32 v88, v164, v180
s_waitcnt lgkmcnt(6)
v_mfma_f32_32x32x16_bf16 v[216:231], a[112:115], v[56:59], 0
ds_read_b64_tr_b16 v[72:73], v20 offset:8192
ds_read_b64_tr_b16 v[74:75], v20 offset:9216
ds_read_b64_tr_b16 v[76:77], v20 offset:10240
ds_read_b64_tr_b16 v[78:79], v20 offset:11264
v_sub_f32 v89, v165, v181
v_add_f32 v164, v164, v251
s_waitcnt lgkmcnt(8)
v_mfma_f32_32x32x16_bf16 v[216:231], a[116:119], v[60:63], v[216:231]
ds_read_b64_tr_b16 v[80:81], v20 offset:12288
ds_read_b64_tr_b16 v[82:83], v20 offset:13312
ds_read_b64_tr_b16 v[84:85], v20 offset:14336
ds_read_b64_tr_b16 v[86:87], v20 offset:15360
v_cvt_pk_bf16_f32 v90, v88, v89
v_add_f32 v165, v165, v251
v_cvt_pk_bf16_f32 v232, v136, v137
v_cvt_pk_bf16_f32 v233, v138, v139
v_cvt_pk_bf16_f32 v234, v140, v141
s_waitcnt lgkmcnt(10)
v_mfma_f32_32x32x16_bf16 v[216:231], a[120:123], v[64:67], v[216:231]
ds_read_b64_tr_b16 v[56:57], v20 offset:16384
ds_read_b64_tr_b16 v[58:59], v20 offset:17408
v_lshlrev_b32 v88, 16, v90
v_and_b32 v89, s59, v90
v_cvt_pk_bf16_f32 v235, v142, v143
v_cvt_pk_bf16_f32 v236, v144, v145
v_cvt_pk_bf16_f32 v237, v146, v147
s_waitcnt lgkmcnt(10)
v_mfma_f32_32x32x16_bf16 v[216:231], a[124:127], v[68:71], v[216:231]
ds_read_b64_tr_b16 v[60:61], v20 offset:18432
ds_read_b64_tr_b16 v[62:63], v20 offset:19456
v_mul_f32 v88, v88, v196
v_mul_f32 v89, v89, v197
v_cvt_pk_bf16_f32 v238, v148, v149
v_cvt_pk_bf16_f32 v239, v150, v151
s_waitcnt lgkmcnt(4)
v_mfma_f32_32x32x16_bf16 v[216:231], a[128:131], v[72:75], v[216:231]
ds_read_b64_tr_b16 v[64:65], v20 offset:20480
ds_read_b64_tr_b16 v[66:67], v20 offset:21504
buffer_store_dwordx4 v[232:235], v248, s[40:43], s86 offen sc1
v_cvt_pk_bf16_f32 v90, v88, v89
v_lshlrev_b32 v88, 16, v90
v_mfma_f32_32x32x16_bf16 v[216:231], a[132:135], v[76:79], v[216:231]
ds_read_b64_tr_b16 v[68:69], v20 offset:22528
ds_read_b64_tr_b16 v[70:71], v20 offset:23552
v_and_b32 v89, s59, v90
v_mul_f32 v88, v88, v250
v_mfma_f32_32x32x16_bf16 v[216:231], a[136:139], v[80:83], v[216:231]
buffer_store_dwordx4 v[236:239], v248, s[40:43], s86 offen offset:1024 sc1
v_mul_f32 v89, v89, v250
v_cvt_pk_bf16_f32 v90, v88, v89
v_mfma_f32_32x32x16_bf16 v[216:231], a[140:143], v[84:87], v[216:231]
v_lshlrev_b32 v88, 16, v90
v_and_b32 v89, s59, v90
s_waitcnt lgkmcnt(0)
v_mfma_f32_32x32x16_bf16 v[216:231], a[144:147], v[56:59], v[216:231]
v_add_f32 v164, v164, v88
v_add_f32 v165, v165, v89
v_mfma_f32_32x32x16_bf16 v[216:231], a[148:151], v[60:63], v[216:231]
v_accvgpr_read_b32 v167, a219
v_lshlrev_b32 v166, 16, v167
s_waitcnt vmcnt(16)
s_barrier
v_mfma_f32_32x32x16_bf16 v[216:231], a[152:155], v[64:67], v[216:231]
ds_read_b64_tr_b16 v[72:73], v20 offset:24576
ds_read_b64_tr_b16 v[74:75], v20 offset:25600
ds_read_b64_tr_b16 v[76:77], v20 offset:26624
ds_read_b64_tr_b16 v[78:79], v20 offset:27648
v_and_b32 v167, s59, v167
v_sub_f32 v88, v166, v182
v_mfma_f32_32x32x16_bf16 v[216:231], a[156:159], v[68:71], v[216:231]
ds_read_b64_tr_b16 v[80:81], v20 offset:28672
ds_read_b64_tr_b16 v[82:83], v20 offset:29696
ds_read_b64_tr_b16 v[84:85], v20 offset:30720
ds_read_b64_tr_b16 v[86:87], v20 offset:31744
v_sub_f32 v89, v167, v183
v_add_f32 v166, v166, v251
s_waitcnt lgkmcnt(6)
v_mfma_f32_32x32x16_bf16 v[216:231], a[160:163], v[72:75], v[216:231]
ds_read_b128 v[56:59], v10 offset:32768
ds_read_b128 v[60:63], v11 offset:32768
v_cvt_pk_bf16_f32 v90, v88, v89
v_add_f32 v167, v167, v251
s_waitcnt lgkmcnt(6)
v_mfma_f32_32x32x16_bf16 v[216:231], a[164:167], v[76:79], v[216:231]
ds_read_b128 v[64:67], v12 offset:32768
ds_read_b128 v[68:71], v13 offset:32768
v_lshlrev_b32 v88, 16, v90
v_and_b32 v89, s59, v90
s_waitcnt lgkmcnt(6)
v_mfma_f32_32x32x16_bf16 v[216:231], a[168:171], v[80:83], v[216:231]
ds_read_b128 v[72:75], v10 offset:40960
v_mul_f32 v88, v88, v198
v_mul_f32 v89, v89, v199
s_waitcnt lgkmcnt(5)
v_mfma_f32_32x32x16_bf16 v[216:231], a[172:175], v[84:87], v[216:231]
ds_read_b128 v[76:79], v11 offset:40960
v_cvt_pk_bf16_f32 v90, v88, v89
v_lshlrev_b32 v88, 16, v90
s_waitcnt lgkmcnt(2)
v_mfma_f32_32x32x16_bf16 v[216:231], a[176:179], v[56:59], v[216:231]
ds_read_b128 v[80:83], v12 offset:40960
v_and_b32 v89, s59, v90
v_mul_f32 v88, v88, v250
v_mfma_f32_32x32x16_bf16 v[216:231], a[180:183], v[60:63], v[216:231]
ds_read_b128 v[84:87], v13 offset:40960
v_mul_f32 v89, v89, v250
v_cvt_pk_bf16_f32 v90, v88, v89
v_mfma_f32_32x32x16_bf16 v[216:231], a[184:187], v[64:67], v[216:231]
v_lshlrev_b32 v88, 16, v90
v_and_b32 v89, s59, v90
v_mfma_f32_32x32x16_bf16 v[216:231], a[188:191], v[68:71], v[216:231]
v_add_f32 v166, v166, v88
v_add_f32 v167, v167, v89
s_waitcnt lgkmcnt(0)
v_mfma_f32_32x32x16_bf16 v[216:231], a[192:195], v[72:75], v[216:231]
v_mfma_f32_32x32x16_bf16 v[216:231], a[196:199], v[76:79], v[216:231]
s_waitcnt vmcnt(10)
s_barrier
v_mfma_f32_32x32x16_bf16 v[216:231], a[200:203], v[80:83], v[216:231]
ds_read_b64_tr_b16 v[56:57], v20 offset:49152
ds_read_b64_tr_b16 v[58:59], v20 offset:50176
ds_read_b64_tr_b16 v[60:61], v20 offset:51200
ds_read_b64_tr_b16 v[62:63], v20 offset:52224
v_mfma_f32_32x32x16_bf16 v[216:231], a[204:207], v[84:87], v[216:231]
ds_read_b64_tr_b16 v[64:65], v20 offset:53248
ds_read_b64_tr_b16 v[66:67], v20 offset:54272
ds_read_b64_tr_b16 v[68:69], v20 offset:55296
ds_read_b64_tr_b16 v[70:71], v20 offset:56320
s_waitcnt lgkmcnt(6)
v_mfma_f32_32x32x16_bf16 v[136:151], a[112:115], v[56:59], 0
ds_read_b64_tr_b16 v[72:73], v20 offset:57344
ds_read_b64_tr_b16 v[74:75], v20 offset:58368
ds_read_b64_tr_b16 v[76:77], v20 offset:59392
ds_read_b64_tr_b16 v[78:79], v20 offset:60416
s_waitcnt lgkmcnt(8)
v_mfma_f32_32x32x16_bf16 v[136:151], a[116:119], v[60:63], v[136:151]
ds_read_b64_tr_b16 v[80:81], v20 offset:61440
ds_read_b64_tr_b16 v[82:83], v20 offset:62464
ds_read_b64_tr_b16 v[84:85], v20 offset:63488
ds_read_b64_tr_b16 v[86:87], v20 offset:64512
v_cvt_pk_bf16_f32 v232, v216, v217
v_cvt_pk_bf16_f32 v233, v218, v219
v_cvt_pk_bf16_f32 v234, v220, v221
s_waitcnt lgkmcnt(10)
v_mfma_f32_32x32x16_bf16 v[136:151], a[120:123], v[64:67], v[136:151]
ds_read_b64_tr_b16 v[56:57], v21 offset:0
ds_read_b64_tr_b16 v[58:59], v21 offset:1024
global_load_dword v46, v47, s[6:7] sc1
v_cvt_pk_bf16_f32 v235, v222, v223
v_cvt_pk_bf16_f32 v236, v224, v225
v_cvt_pk_bf16_f32 v237, v226, v227
s_waitcnt lgkmcnt(10)
v_mfma_f32_32x32x16_bf16 v[136:151], a[124:127], v[68:71], v[136:151]
ds_read_b64_tr_b16 v[60:61], v21 offset:2048
ds_read_b64_tr_b16 v[62:63], v21 offset:3072
v_cvt_pk_bf16_f32 v238, v228, v229
v_cvt_pk_bf16_f32 v239, v230, v231
s_waitcnt lgkmcnt(4)
v_mfma_f32_32x32x16_bf16 v[136:151], a[128:131], v[72:75], v[136:151]
ds_read_b64_tr_b16 v[64:65], v21 offset:4096
ds_read_b64_tr_b16 v[66:67], v21 offset:5120
buffer_store_dwordx4 v[232:235], v248, s[40:43], s87 offen sc1
v_mfma_f32_32x32x16_bf16 v[136:151], a[132:135], v[76:79], v[136:151]
ds_read_b64_tr_b16 v[68:69], v21 offset:6144
ds_read_b64_tr_b16 v[70:71], v21 offset:7168
v_mfma_f32_32x32x16_bf16 v[136:151], a[136:139], v[80:83], v[136:151]
buffer_store_dwordx4 v[236:239], v248, s[40:43], s87 offen offset:1024 sc1
v_mfma_f32_32x32x16_bf16 v[136:151], a[140:143], v[84:87], v[136:151]
s_waitcnt lgkmcnt(0)
v_mfma_f32_32x32x16_bf16 v[136:151], a[144:147], v[56:59], v[136:151]
v_mfma_f32_32x32x16_bf16 v[136:151], a[148:151], v[60:63], v[136:151]
s_waitcnt vmcnt(5)
s_barrier
v_mfma_f32_32x32x16_bf16 v[136:151], a[152:155], v[64:67], v[136:151]
ds_read_b64_tr_b16 v[72:73], v21 offset:8192
ds_read_b64_tr_b16 v[74:75], v21 offset:9216
ds_read_b64_tr_b16 v[76:77], v21 offset:10240
ds_read_b64_tr_b16 v[78:79], v21 offset:11264
s_waitcnt vmcnt(2)
v_readfirstlane_b32 s98, v46
s_cmp_ge_u32 s98, 7
s_cbranch_scc1 L_sok6
s_mov_b32 s99, 0
L_spin6:
global_load_dword v46, v47, s[6:7] sc1
s_waitcnt vmcnt(0)
v_readfirstlane_b32 s98, v46
s_cmp_ge_u32 s98, 7
s_cbranch_scc1 L_sok6
s_add_u32 s99, s99, 1
s_cmp_gt_u32 s99, 400000
s_cbranch_scc1 L_sok6
s_sleep 3
s_branch L_spin6
L_sok6:
buffer_load_dwordx4 v[200:203], v248, s[40:43], s64 offen sc1
v_mfma_f32_32x32x16_bf16 v[136:151], a[156:159], v[68:71], v[136:151]
ds_read_b64_tr_b16 v[80:81], v21 offset:12288
ds_read_b64_tr_b16 v[82:83], v21 offset:13312
ds_read_b64_tr_b16 v[84:85], v21 offset:14336
ds_read_b64_tr_b16 v[86:87], v21 offset:15360
buffer_load_dwordx4 v[204:207], v248, s[40:43], s64 offen offset:1024 sc1
s_waitcnt lgkmcnt(6)
v_mfma_f32_32x32x16_bf16 v[136:151], a[160:163], v[72:75], v[136:151]
ds_read_b128 v[56:59], v14 offset:16384
ds_read_b128 v[60:63], v15 offset:16384
buffer_load_dwordx4 v[208:211], v248, s[40:43], s65 offen sc1
s_waitcnt lgkmcnt(6)
v_mfma_f32_32x32x16_bf16 v[136:151], a[164:167], v[76:79], v[136:151]
ds_read_b128 v[64:67], v16 offset:16384
ds_read_b128 v[68:71], v17 offset:16384
buffer_load_dwordx4 v[212:215], v248, s[40:43], s65 offen offset:1024 sc1
s_waitcnt lgkmcnt(6)
v_mfma_f32_32x32x16_bf16 v[136:151], a[168:171], v[80:83], v[136:151]
ds_read_b128 v[72:75], v14 offset:24576
buffer_load_dwordx4 v[216:219], v248, s[40:43], s80 offen sc1
s_waitcnt lgkmcnt(5)
v_mfma_f32_32x32x16_bf16 v[136:151], a[172:175], v[84:87], v[136:151]
ds_read_b128 v[76:79], v15 offset:24576
buffer_load_dwordx4 v[220:223], v248, s[40:43], s80 offen offset:1024 sc1
s_waitcnt lgkmcnt(2)
v_mfma_f32_32x32x16_bf16 v[136:151], a[176:179], v[56:59], v[136:151]
ds_read_b128 v[80:83], v16 offset:24576
v_mfma_f32_32x32x16_bf16 v[136:151], a[180:183], v[60:63], v[136:151]
ds_read_b128 v[84:87], v17 offset:24576
v_mfma_f32_32x32x16_bf16 v[136:151], a[184:187], v[64:67], v[136:151]
v_mfma_f32_32x32x16_bf16 v[136:151], a[188:191], v[68:71], v[136:151]
s_waitcnt lgkmcnt(0)
v_mfma_f32_32x32x16_bf16 v[136:151], a[192:195], v[72:75], v[136:151]
v_mfma_f32_32x32x16_bf16 v[136:151], a[196:199], v[76:79], v[136:151]
v_mfma_f32_32x32x16_bf16 v[136:151], a[200:203], v[80:83], v[136:151]
v_mfma_f32_32x32x16_bf16 v[136:151], a[204:207], v[84:87], v[136:151]
s_nop 11
v_add_f32 v136, v136, v152
v_add_f32 v137, v137, v153
v_add_f32 v138, v138, v154
v_add_f32 v139, v139, v155
v_add_f32 v140, v140, v156
v_add_f32 v141, v141, v157
v_add_f32 v142, v142, v158
v_add_f32 v143, v143, v159
v_add_f32 v144, v144, v160
v_add_f32 v145, v145, v161
v_add_f32 v146, v146, v162
v_add_f32 v147, v147, v163
v_add_f32 v148, v148, v164
v_add_f32 v149, v149, v165
v_add_f32 v150, v150, v166
v_add_f32 v151, v151, v167
buffer_load_dwordx4 v[224:227], v248, s[40:43], s81 offen sc1
buffer_load_dwordx4 v[228:231], v248, s[40:43], s81 offen offset:1024 sc1
buffer_load_dwordx4 v[232:235], v248, s[40:43], s89 offen sc1
buffer_load_dwordx4 v[236:239], v248, s[40:43], s89 offen offset:1024 sc1
buffer_load_dwordx4 v[240:243], v248, s[40:43], s90 offen sc1
buffer_load_dwordx4 v[244:247], v248, s[40:43], s90 offen offset:1024 sc1
s_waitcnt vmcnt(11)
v_dot2_f32_bf16 v136, v200, s57, v136
v_dot2_f32_bf16 v137, v200, s58, v137
v_dot2_f32_bf16 v138, v201, s57, v138
v_dot2_f32_bf16 v139, v201, s58, v139
v_dot2_f32_bf16 v140, v202, s57, v140
v_dot2_f32_bf16 v141, v202, s58, v141
v_dot2_f32_bf16 v142, v203, s57, v142
v_dot2_f32_bf16 v143, v203, s58, v143
s_waitcnt vmcnt(10)
v_dot2_f32_bf16 v144, v204, s57, v144
v_dot2_f32_bf16 v145, v204, s58, v145
v_dot2_f32_bf16 v146, v205, s57, v146
v_dot2_f32_bf16 v147, v205, s58, v147
v_dot2_f32_bf16 v148, v206, s57, v148
v_dot2_f32_bf16 v149, v206, s58, v149
v_dot2_f32_bf16 v150, v207, s57, v150
v_dot2_f32_bf16 v151, v207, s58, v151
s_waitcnt vmcnt(9)
v_dot2_f32_bf16 v136, v208, s57, v136
v_dot2_f32_bf16 v137, v208, s58, v137
v_dot2_f32_bf16 v138, v209, s57, v138
v_dot2_f32_bf16 v139, v209, s58, v139
v_dot2_f32_bf16 v140, v210, s57, v140
v_dot2_f32_bf16 v141, v210, s58, v141
v_dot2_f32_bf16 v142, v211, s57, v142
v_dot2_f32_bf16 v143, v211, s58, v143
s_waitcnt vmcnt(8)
v_dot2_f32_bf16 v144, v212, s57, v144
v_dot2_f32_bf16 v145, v212, s58, v145
v_dot2_f32_bf16 v146, v213, s57, v146
v_dot2_f32_bf16 v147, v213, s58, v147
v_dot2_f32_bf16 v148, v214, s57, v148
v_dot2_f32_bf16 v149, v214, s58, v149
v_dot2_f32_bf16 v150, v215, s57, v150
v_dot2_f32_bf16 v151, v215, s58, v151
s_waitcnt vmcnt(7)
v_dot2_f32_bf16 v136, v216, s57, v136
v_dot2_f32_bf16 v137, v216, s58, v137
v_dot2_f32_bf16 v138, v217, s57, v138
v_dot2_f32_bf16 v139, v217, s58, v139
v_dot2_f32_bf16 v140, v218, s57, v140
v_dot2_f32_bf16 v141, v218, s58, v141
v_dot2_f32_bf16 v142, v219, s57, v142
v_dot2_f32_bf16 v143, v219, s58, v143
s_waitcnt vmcnt(6)
v_dot2_f32_bf16 v144, v220, s57, v144
v_dot2_f32_bf16 v145, v220, s58, v145
v_dot2_f32_bf16 v146, v221, s57, v146
v_dot2_f32_bf16 v147, v221, s58, v147
v_dot2_f32_bf16 v148, v222, s57, v148
v_dot2_f32_bf16 v149, v222, s58, v149
v_dot2_f32_bf16 v150, v223, s57, v150
v_dot2_f32_bf16 v151, v223, s58, v151
s_waitcnt vmcnt(5)
v_max3_u32 v1, v224, v225, v226
s_waitcnt vmcnt(4)
v_max3_u32 v1, v1, v227, v228
v_max3_u32 v1, v1, v229, v230
s_waitcnt vmcnt(3)
v_max3_u32 v1, v1, v231, v232
v_max3_u32 v1, v1, v233, v234
s_waitcnt vmcnt(2)
v_max3_u32 v1, v1, v235, v236
v_max3_u32 v1, v1, v237, v238
s_waitcnt vmcnt(1)
v_max3_u32 v1, v1, v239, v240
v_max3_u32 v1, v1, v241, v242
s_waitcnt vmcnt(0)
v_max3_u32 v1, v1, v243, v244
v_max3_u32 v1, v1, v245, v246
v_max_u32 v1, v1, v247
v_cmp_eq_u32 vcc, -1, v1
s_nop 4
s_cmp_eq_u64 vcc, 0
s_cbranch_scc1 L_inok0
s_mov_b32 s99, 0
L_inre0:
buffer_load_dwordx4 v[224:227], v248, s[40:43], s81 offen sc1
buffer_load_dwordx4 v[228:231], v248, s[40:43], s81 offen offset:1024 sc1
buffer_load_dwordx4 v[232:235], v248, s[40:43], s89 offen sc1
buffer_load_dwordx4 v[236:239], v248, s[40:43], s89 offen offset:1024 sc1
buffer_load_dwordx4 v[240:243], v248, s[40:43], s90 offen sc1
buffer_load_dwordx4 v[244:247], v248, s[40:43], s90 offen offset:1024 sc1
s_waitcnt vmcnt(0)
v_max3_u32 v1, v224, v225, v226
v_max3_u32 v1, v1, v227, v228
v_max3_u32 v1, v1, v229, v230
v_max3_u32 v1, v1, v231, v232
v_max3_u32 v1, v1, v233, v234
v_max3_u32 v1, v1, v235, v236
v_max3_u32 v1, v1, v237, v238
v_max3_u32 v1, v1, v239, v240
v_max3_u32 v1, v1, v241, v242
v_max3_u32 v1, v1, v243, v244
v_max3_u32 v1, v1, v245, v246
v_max_u32 v1, v1, v247
v_cmp_eq_u32 vcc, -1, v1
s_nop 4
s_cmp_eq_u64 vcc, 0
s_cbranch_scc1 L_inok0
s_add_u32 s99, s99, 1
s_cmp_gt_u32 s99, 400000
s_cbranch_scc1 L_inok0
s_branch L_inre0
L_inok0:
v_dot2_f32_bf16 v136, v224, s57, v136
v_dot2_f32_bf16 v137, v224, s58, v137
v_dot2_f32_bf16 v138, v225, s57, v138
v_dot2_f32_bf16 v139, v225, s58, v139
v_dot2_f32_bf16 v140, v226, s57, v140
v_dot2_f32_bf16 v141, v226, s58, v141
v_dot2_f32_bf16 v142, v227, s57, v142
v_dot2_f32_bf16 v143, v227, s58, v143
v_dot2_f32_bf16 v144, v228, s57, v144
v_dot2_f32_bf16 v145, v228, s58, v145
v_dot2_f32_bf16 v146, v229, s57, v146
v_dot2_f32_bf16 v147, v229, s58, v147
v_dot2_f32_bf16 v148, v230, s57, v148
v_dot2_f32_bf16 v149, v230, s58, v149
v_dot2_f32_bf16 v150, v231, s57, v150
v_dot2_f32_bf16 v151, v231, s58, v151
v_dot2_f32_bf16 v136, v232, s57, v136
v_dot2_f32_bf16 v137, v232, s58, v137
v_dot2_f32_bf16 v138, v233, s57, v138
v_dot2_f32_bf16 v139, v233, s58, v139
v_dot2_f32_bf16 v140, v234, s57, v140
v_dot2_f32_bf16 v141, v234, s58, v141
v_dot2_f32_bf16 v142, v235, s57, v142
v_dot2_f32_bf16 v143, v235, s58, v143
v_dot2_f32_bf16 v144, v236, s57, v144
v_dot2_f32_bf16 v145, v236, s58, v145
v_dot2_f32_bf16 v146, v237, s57, v146
v_dot2_f32_bf16 v147, v237, s58, v147
v_dot2_f32_bf16 v148, v238, s57, v148
v_dot2_f32_bf16 v149, v238, s58, v149
v_dot2_f32_bf16 v150, v239, s57, v150
v_dot2_f32_bf16 v151, v239, s58, v151
v_dot2_f32_bf16 v136, v240, s57, v136
v_dot2_f32_bf16 v137, v240, s58, v137
v_dot2_f32_bf16 v138, v241, s57, v138
v_dot2_f32_bf16 v139, v241, s58, v139
v_dot2_f32_bf16 v140, v242, s57, v140
v_dot2_f32_bf16 v141, v242, s58, v141
v_dot2_f32_bf16 v142, v243, s57, v142
v_dot2_f32_bf16 v143, v243, s58, v143
v_dot2_f32_bf16 v144, v244, s57, v144
v_dot2_f32_bf16 v145, v244, s58, v145
v_dot2_f32_bf16 v146, v245, s57, v146
v_dot2_f32_bf16 v147, v245, s58, v147
v_dot2_f32_bf16 v148, v246, s57, v148
v_dot2_f32_bf16 v149, v246, s58, v149
v_dot2_f32_bf16 v150, v247, s57, v150
v_dot2_f32_bf16 v151, v247, s58, v151
buffer_store_dword v136, v252, s[44:47], 0 offen
s_mov_b32 s51, 1792
buffer_store_dword v137, v252, s[44:47], s51 offen
s_mov_b32 s51, 3584
buffer_store_dword v138, v252, s[44:47], s51 offen
s_mov_b32 s51, 5376
buffer_store_dword v139, v252, s[44:47], s51 offen
s_mov_b32 s51, 7168
buffer_store_dword v140, v252, s[44:47], s51 offen
s_mov_b32 s51, 8960
buffer_store_dword v141, v252, s[44:47], s51 offen
s_mov_b32 s51, 10752
buffer_store_dword v142, v252, s[44:47], s51 offen
s_mov_b32 s51, 12544
buffer_store_dword v143, v252, s[44:47], s51 offen
s_mov_b32 s51, 14336
buffer_store_dword v144, v252, s[44:47], s51 offen
s_mov_b32 s51, 16128
buffer_store_dword v145, v252, s[44:47], s51 offen
s_mov_b32 s51, 17920
buffer_store_dword v146, v252, s[44:47], s51 offen
s_mov_b32 s51, 19712
buffer_store_dword v147, v252, s[44:47], s51 offen
s_mov_b32 s51, 21504
buffer_store_dword v148, v252, s[44:47], s51 offen
s_mov_b32 s51, 23296
buffer_store_dword v149, v252, s[44:47], s51 offen
s_mov_b32 s51, 25088
buffer_store_dword v150, v252, s[44:47], s51 offen
s_mov_b32 s51, 26880
buffer_store_dword v151, v252, s[44:47], s51 offen
s_endpgm
L_help:
s_waitcnt lgkmcnt(0)
s_nop 0
s_mov_b32 s57, 0x00003f80
s_mov_b32 s58, 0x3f800000
s_cmp_ge_u32 s2, 28
s_cbranch_scc1 L_h0
v_lshrrev_b32 v1, 3, v0
s_mul_i32 s98, s3, 112
v_add_u32 v1, s98, v1
v_mul_u32_u24 v1, 3584, v1
v_and_b32 v2, 7, v0
v_lshl_add_u32 v1, v2, 4, v1
s_lshl_b32 s98, s2, 7
v_add_u32 v1, s98, v1
global_load_dwordx4 v[64:67], v1, s[84:85]
v_add_u32 v1, 28672, v1
global_load_dwordx4 v[68:71], v1, s[84:85]
v_add_u32 v1, 28672, v1
global_load_dwordx4 v[72:75], v1, s[84:85]
v_add_u32 v1, 28672, v1
global_load_dwordx4 v[76:79], v1, s[84:85]
v_add_u32 v1, 28672, v1
global_load_dwordx4 v[80:83], v1, s[84:85]
v_add_u32 v1, 28672, v1
global_load_dwordx4 v[84:87], v1, s[84:85]
v_add_u32 v1, 28672, v1
global_load_dwordx4 v[88:91], v1, s[84:85]
v_add_u32 v1, 28672, v1
global_load_dwordx4 v[92:95], v1, s[84:85]
v_add_u32 v1, 28672, v1
global_load_dwordx4 v[96:99], v1, s[84:85]
v_add_u32 v1, 28672, v1
global_load_dwordx4 v[100:103], v1, s[84:85]
v_add_u32 v1, 28672, v1
global_load_dwordx4 v[104:107], v1, s[84:85]
v_add_u32 v1, 28672, v1
global_load_dwordx4 v[108:111], v1, s[84:85]
v_add_u32 v1, 28672, v1
global_load_dwordx4 v[112:115], v1, s[84:85]
v_add_u32 v1, 28672, v1
global_load_dwordx4 v[116:119], v1, s[84:85]
s_cmp_eq_u32 s3, 0
s_cbranch_scc1 L_t01
s_bfe_u32 s98, s2, 0x10003
s_mul_i32 s98, s98, 3
s_add_u32 s98, s98, s3
s_sub_u32 s98, s98, 1
s_lshl_b32 s98, s98, 13
v_lshlrev_b32 v2, 7, v0
v_add_u32 v2, s98, v2
v_min_u32 v2, L_codeend-L_pc-4, v2
global_load_dword v21, v2, s[52:53]
s_mul_i32 s8, s2, 3
s_add_u32 s8, s8, s3
s_sub_u32 s8, s8, 1
s_mul_i32 s9, s8, 4224
v_min_u32 v4, 32, v0
v_lshlrev_b32 v4, 7, v4
v_add_u32 v3, s9, v4
v_min_u32 v3, 401404, v3
global_load_dword v24, v3, s[72:73]
global_load_dword v25, v3, s[70:71]
s_branch L_t11
L_t01:
s_lshl_b32 s98, s2, 8
s_add_u32 s98, s98, 262144
v_lshl_add_u32 v2, v0, 2, s98
global_load_dword v21, v2, s[6:7]
v_mov_b32 v2, 128
global_load_dword v24, v2, s[94:95] sc1
v_mov_b32 v2, 0
global_load_dword v25, v2, s[86:87]
L_t11:
v_mov_b32 v32, 0
v_mov_b32 v33, 0
v_mov_b32 v34, 0
v_mov_b32 v35, 0
v_mov_b32 v36, 0
v_mov_b32 v37, 0
v_mov_b32 v38, 0
v_mov_b32 v39, 0
s_waitcnt vmcnt(16)
v_dot2_f32_bf16 v32, v64, s57, v32
v_dot2_f32_bf16 v33, v64, s58, v33
v_dot2_f32_bf16 v34, v65, s57, v34
v_dot2_f32_bf16 v35, v65, s58, v35
v_dot2_f32_bf16 v36, v66, s57, v36
v_dot2_f32_bf16 v37, v66, s58, v37
v_dot2_f32_bf16 v38, v67, s57, v38
v_dot2_f32_bf16 v39, v67, s58, v39
s_waitcnt vmcnt(15)
v_dot2_f32_bf16 v32, v68, s57, v32
v_dot2_f32_bf16 v33, v68, s58, v33
v_dot2_f32_bf16 v34, v69, s57, v34
v_dot2_f32_bf16 v35, v69, s58, v35
v_dot2_f32_bf16 v36, v70, s57, v36
v_dot2_f32_bf16 v37, v70, s58, v37
v_dot2_f32_bf16 v38, v71, s57, v38
v_dot2_f32_bf16 v39, v71, s58, v39
s_waitcnt vmcnt(14)
v_dot2_f32_bf16 v32, v72, s57, v32
v_dot2_f32_bf16 v33, v72, s58, v33
v_dot2_f32_bf16 v34, v73, s57, v34
v_dot2_f32_bf16 v35, v73, s58, v35
v_dot2_f32_bf16 v36, v74, s57, v36
v_dot2_f32_bf16 v37, v74, s58, v37
v_dot2_f32_bf16 v38, v75, s57, v38
v_dot2_f32_bf16 v39, v75, s58, v39
s_waitcnt vmcnt(13)
v_dot2_f32_bf16 v32, v76, s57, v32
v_dot2_f32_bf16 v33, v76, s58, v33
v_dot2_f32_bf16 v34, v77, s57, v34
v_dot2_f32_bf16 v35, v77, s58, v35
v_dot2_f32_bf16 v36, v78, s57, v36
v_dot2_f32_bf16 v37, v78, s58, v37
v_dot2_f32_bf16 v38, v79, s57, v38
v_dot2_f32_bf16 v39, v79, s58, v39
s_waitcnt vmcnt(12)
v_dot2_f32_bf16 v32, v80, s57, v32
v_dot2_f32_bf16 v33, v80, s58, v33
v_dot2_f32_bf16 v34, v81, s57, v34
v_dot2_f32_bf16 v35, v81, s58, v35
v_dot2_f32_bf16 v36, v82, s57, v36
v_dot2_f32_bf16 v37, v82, s58, v37
v_dot2_f32_bf16 v38, v83, s57, v38
v_dot2_f32_bf16 v39, v83, s58, v39
s_waitcnt vmcnt(11)
v_dot2_f32_bf16 v32, v84, s57, v32
v_dot2_f32_bf16 v33, v84, s58, v33
v_dot2_f32_bf16 v34, v85, s57, v34
v_dot2_f32_bf16 v35, v85, s58, v35
v_dot2_f32_bf16 v36, v86, s57, v36
v_dot2_f32_bf16 v37, v86, s58, v37
v_dot2_f32_bf16 v38, v87, s57, v38
v_dot2_f32_bf16 v39, v87, s58, v39
s_waitcnt vmcnt(10)
v_dot2_f32_bf16 v32, v88, s57, v32
v_dot2_f32_bf16 v33, v88, s58, v33
v_dot2_f32_bf16 v34, v89, s57, v34
v_dot2_f32_bf16 v35, v89, s58, v35
v_dot2_f32_bf16 v36, v90, s57, v36
v_dot2_f32_bf16 v37, v90, s58, v37
v_dot2_f32_bf16 v38, v91, s57, v38
v_dot2_f32_bf16 v39, v91, s58, v39
s_waitcnt vmcnt(9)
v_dot2_f32_bf16 v32, v92, s57, v32
v_dot2_f32_bf16 v33, v92, s58, v33
v_dot2_f32_bf16 v34, v93, s57, v34
v_dot2_f32_bf16 v35, v93, s58, v35
v_dot2_f32_bf16 v36, v94, s57, v36
v_dot2_f32_bf16 v37, v94, s58, v37
v_dot2_f32_bf16 v38, v95, s57, v38
v_dot2_f32_bf16 v39, v95, s58, v39
s_waitcnt vmcnt(8)
v_dot2_f32_bf16 v32, v96, s57, v32
v_dot2_f32_bf16 v33, v96, s58, v33
v_dot2_f32_bf16 v34, v97, s57, v34
v_dot2_f32_bf16 v35, v97, s58, v35
v_dot2_f32_bf16 v36, v98, s57, v36
v_dot2_f32_bf16 v37, v98, s58, v37
v_dot2_f32_bf16 v38, v99, s57, v38
v_dot2_f32_bf16 v39, v99, s58, v39
s_waitcnt vmcnt(7)
v_dot2_f32_bf16 v32, v100, s57, v32
v_dot2_f32_bf16 v33, v100, s58, v33
v_dot2_f32_bf16 v34, v101, s57, v34
v_dot2_f32_bf16 v35, v101, s58, v35
v_dot2_f32_bf16 v36, v102, s57, v36
v_dot2_f32_bf16 v37, v102, s58, v37
v_dot2_f32_bf16 v38, v103, s57, v38
v_dot2_f32_bf16 v39, v103, s58, v39
s_waitcnt vmcnt(6)
v_dot2_f32_bf16 v32, v104, s57, v32
v_dot2_f32_bf16 v33, v104, s58, v33
v_dot2_f32_bf16 v34, v105, s57, v34
v_dot2_f32_bf16 v35, v105, s58, v35
v_dot2_f32_bf16 v36, v106, s57, v36
v_dot2_f32_bf16 v37, v106, s58, v37
v_dot2_f32_bf16 v38, v107, s57, v38
v_dot2_f32_bf16 v39, v107, s58, v39
s_waitcnt vmcnt(5)
v_dot2_f32_bf16 v32, v108, s57, v32
v_dot2_f32_bf16 v33, v108, s58, v33
v_dot2_f32_bf16 v34, v109, s57, v34
v_dot2_f32_bf16 v35, v109, s58, v35
v_dot2_f32_bf16 v36, v110, s57, v36
v_dot2_f32_bf16 v37, v110, s58, v37
v_dot2_f32_bf16 v38, v111, s57, v38
v_dot2_f32_bf16 v39, v111, s58, v39
s_waitcnt vmcnt(4)
v_dot2_f32_bf16 v32, v112, s57, v32
v_dot2_f32_bf16 v33, v112, s58, v33
v_dot2_f32_bf16 v34, v113, s57, v34
v_dot2_f32_bf16 v35, v113, s58, v35
v_dot2_f32_bf16 v36, v114, s57, v36
v_dot2_f32_bf16 v37, v114, s58, v37
v_dot2_f32_bf16 v38, v115, s57, v38
v_dot2_f32_bf16 v39, v115, s58, v39
s_waitcnt vmcnt(3)
v_dot2_f32_bf16 v32, v116, s57, v32
v_dot2_f32_bf16 v33, v116, s58, v33
v_dot2_f32_bf16 v34, v117, s57, v34
v_dot2_f32_bf16 v35, v117, s58, v35
v_dot2_f32_bf16 v36, v118, s57, v36
v_dot2_f32_bf16 v37, v118, s58, v37
v_dot2_f32_bf16 v38, v119, s57, v38
v_dot2_f32_bf16 v39, v119, s58, v39
s_nop 3
v_lshlrev_b32 v1, 5, v0
s_lshl_b32 s98, s3, 11
v_add_u32 v1, s98, v1
ds_write_b128 v1, v[32:35]
ds_write_b128 v1, v[36:39] offset:16
s_waitcnt lgkmcnt(0)
s_barrier
v_lshrrev_b32 v1, 3, v0
v_lshlrev_b32 v1, 5, v1
v_and_b32 v2, 7, v0
v_lshl_add_u32 v1, v2, 2, v1
v_add_u32 v1, s98, v1
ds_read_b32 v40, v1 offset:0
ds_read_b32 v41, v1 offset:256
ds_read_b32 v42, v1 offset:512
ds_read_b32 v43, v1 offset:768
ds_read_b32 v44, v1 offset:1024
ds_read_b32 v45, v1 offset:1280
ds_read_b32 v46, v1 offset:1536
ds_read_b32 v47, v1 offset:1792
s_waitcnt lgkmcnt(0)
v_add_f32 v40, v40, v41
v_add_f32 v40, v40, v42
v_add_f32 v40, v40, v43
v_add_f32 v40, v40, v44
v_add_f32 v40, v40, v45
v_add_f32 v40, v40, v46
v_add_f32 v40, v40, v47
v_lshlrev_b32 v1, 2, v0
s_lshl_b32 s98, s3, 8
v_add_u32 v2, s98, v1
ds_write_b32 v2, v40 offset:8192
s_waitcnt lgkmcnt(0)
s_barrier
s_cmp_lg_u32 s3, 0
s_cbranch_scc1 L_h1
ds_read_b32 v40, v1 offset:8192
ds_read_b32 v41, v1 offset:8448
ds_read_b32 v42, v1 offset:8704
ds_read_b32 v43, v1 offset:8960
s_waitcnt lgkmcnt(0)
v_add_f32 v40, v40, v41
v_add_f32 v42, v42, v43
v_add_f32 v40, v40, v42
s_lshl_b32 s98, s2, 8
s_add_u32 s98, s98, 262144
v_add_u32 v1, s98, v1
global_store_dword v1, v40, s[6:7] sc1
s_waitcnt vmcnt(0)
s_branch L_hsig
L_h0:
s_cmp_eq_u32 s3, 0
s_cbranch_scc1 L_t02
s_bfe_u32 s98, s2, 0x10003
s_mul_i32 s98, s98, 3
s_add_u32 s98, s98, s3
s_sub_u32 s98, s98, 1
s_lshl_b32 s98, s98, 13
v_lshlrev_b32 v2, 7, v0
v_add_u32 v2, s98, v2
v_min_u32 v2, L_codeend-L_pc-4, v2
global_load_dword v21, v2, s[52:53]
s_mul_i32 s8, s2, 3
s_add_u32 s8, s8, s3
s_sub_u32 s8, s8, 1
s_mul_i32 s9, s8, 4224
v_min_u32 v4, 32, v0
v_lshlrev_b32 v4, 7, v4
v_add_u32 v3, s9, v4
v_min_u32 v3, 401404, v3
global_load_dword v24, v3, s[72:73]
global_load_dword v25, v3, s[70:71]
s_branch L_t12
L_t02:
s_lshl_b32 s98, s2, 8
s_add_u32 s98, s98, 262144
v_lshl_add_u32 v2, v0, 2, s98
global_load_dword v21, v2, s[6:7]
v_mov_b32 v2, 128
global_load_dword v24, v2, s[94:95] sc1
v_mov_b32 v2, 0
global_load_dword v25, v2, s[86:87]
L_t12:
s_cmp_lg_u32 s3, 0
s_cbranch_scc1 L_h1
s_cmp_lg_u32 s2, 31
s_cbranch_scc1 L_hsig
v_lshlrev_b32 v1, 8, v0
v_mov_b32 v2, 0
global_store_dword v1, v2, s[6:7] sc1
v_add_u32 v1, 0x4000, v1
global_store_dword v1, v2, s[6:7] sc1
s_waitcnt vmcnt(0)
L_hsig:
s_mov_b64 exec, 1
v_mov_b32 v1, 128
v_mov_b32 v2, 1
global_atomic_add v1, v2, s[94:95] sc1
s_mov_b64 exec, -1
L_h1:
s_lshl_b32 s8, s2, 2
s_add_u32 s8, s8, s3
s_mul_i32 s9, s8, 12544
v_lshlrev_b32 v2, 7, v0
v_add_u32 v3, s9, v2
global_load_dword v20, v3, s[88:89]
v_min_u32 v4, 33, v0
v_lshlrev_b32 v4, 7, v4
v_add_u32 v4, 8192, v4
v_add_u32 v3, s9, v4
global_load_dword v21, v3, s[88:89]
s_mul_i32 s9, s8, 3200
v_min_u32 v4, 24, v0
v_lshlrev_b32 v4, 7, v4
v_add_u32 v3, s9, v4
v_min_u32 v3, 401404, v3
global_load_dword v22, v3, s[74:75]
global_load_dword v23, v3, s[76:77]
s_cmp_lg_u32 s3, 0
s_cbranch_scc1 L_h2
v_lshlrev_b32 v2, 21, v0
v_min_u32 v3, 3670012, v2
global_load_dword v10, v3, s[92:93]
v_min_u32 v3, 0xe00000, v2
global_load_dword v11, v3, s[6:7]
L_h2:
s_lshl_b32 s8, s2, 2
s_add_u32 s8, s8, s3
v_mov_b32 v44, -1
v_mov_b32 v45, -1
v_mov_b32 v46, -1
v_mov_b32 v47, -1
v_lshlrev_b32 v1, 4, v0
L_mk:
s_mul_i32 s9, s8, 3121
s_lshr_b32 s9, s9, 16
s_mul_i32 s10, s9, 21
s_sub_u32 s10, s8, s10
s_mul_i32 s11, s10, 86
s_lshr_b32 s11, s11, 8
s_mul_i32 s12, s11, 3
s_sub_u32 s12, s10, s12
s_add_u32 s12, s12, s11
s_add_u32 s12, s12, 4
s_cmp_ge_u32 s12, 7
s_cselect_b32 s13, 7, 0
s_sub_u32 s12, s12, s13
s_mul_i32 s11, s11, 7
s_add_u32 s11, s11, s12
s_lshl_b32 s11, s11, 13
s_mul_i32 s9, s9, 401408
s_add_u32 s9, s9, s11
s_add_u32 s9, s9, 1048576
v_add_u32 v2, s9, v1
global_store_dwordx4 v2, v[44:47], s[6:7] sc1
v_add_u32 v2, 1024, v2
global_store_dwordx4 v2, v[44:47], s[6:7] sc1
v_add_u32 v2, 1024, v2
global_store_dwordx4 v2, v[44:47], s[6:7] sc1
v_add_u32 v2, 1024, v2
global_store_dwordx4 v2, v[44:47], s[6:7] sc1
v_add_u32 v2, 1024, v2
global_store_dwordx4 v2, v[44:47], s[6:7] sc1
v_add_u32 v2, 1024, v2
global_store_dwordx4 v2, v[44:47], s[6:7] sc1
v_add_u32 v2, 1024, v2
global_store_dwordx4 v2, v[44:47], s[6:7] sc1
v_add_u32 v2, 1024, v2
global_store_dwordx4 v2, v[44:47], s[6:7] sc1
s_waitcnt vmcnt(0)
s_add_u32 s8, s8, 128
s_cmp_lt_u32 s8, 672
s_cbranch_scc1 L_mk
s_barrier
s_cmp_lg_u32 s3, 0
s_cbranch_scc1 L_exit
s_mov_b64 exec, 1
v_mov_b32 v1, 0
v_mov_b32 v2, 1
global_atomic_add v1, v2, s[94:95] sc1
L_exit:
s_endpgm
L_codeend:
.section .rodata,"a"
.p2align 6
.amdhsa_kernel parallel_sum__ssm_conv_s5__mixer_channel_mlp__prompt_kernel
  .amdhsa_next_free_vgpr 512
  .amdhsa_next_free_sgpr 102
  .amdhsa_accum_offset 256
  .amdhsa_group_segment_fixed_size 0
  .amdhsa_kernarg_size 136
  .amdhsa_user_sgpr_count 2
  .amdhsa_user_sgpr_kernarg_segment_ptr 1
  .amdhsa_system_sgpr_workgroup_id_x 1
  .amdhsa_float_denorm_mode_32 3
.end_amdhsa_kernel
```
